```python
import torch

def _softmax(x, axis=-1):
    return torch.softmax(x, dim=axis)

def _gelu(x):
    return torch.nn.functional.gelu(x, approximate='tanh')

def _silu(x):
    return torch.nn.functional.silu(x)

def _sigmoid(x):
    return torch.sigmoid(x)

def _layernorm(x, axis=-1, eps=1e-05):
    m = x.mean(dim=axis, keepdim=True)
    v = x.var(dim=axis, keepdim=True, unbiased=False)
    return (x - m) / torch.sqrt(v + eps)

def _scatter_add(tgt, idx, src, axis=0):
    return tgt.clone().index_add_(axis, idx, src)

def _segment_sum(src, seg, n):
    out = torch.zeros((n,) + src.shape[1:], dtype=src.dtype)
    return out.index_add_(0, seg, src)

def _pad(x, pw):
    flat = tuple((v for pair in reversed(pw) for v in pair))
    return torch.nn.functional.pad(x, flat)
kernel_name = 'standalone__autoregressive_conv_wavernn__speech'

def setup_inputs():

    _w = lambda a: (lambda t: t.to(torch.bfloat16) if t.is_floating_point() else t)(torch.as_tensor(a))
    B, T, D, K = (2, 1000, 512, 5)
    return {'x': _w((lambda *s: torch.randn(*s, dtype=torch.bfloat16) * 0.05)(B, T, D)), 'w': _w((lambda *s: torch.randn(*s, dtype=torch.bfloat16) * 0.05)(K, D, 2 * D))}

def reference(x, w):
    B, T, D = x.shape
    K = w.shape[0]
    dil = 2
    pad = (K - 1) * dil
    xp = _pad(x, ((0, 0), (pad, 0), (0, 0)))
    h = torch.einsum('btd,de->bte', xp[:, 0:T, :], w[0])
    for i in range(1, K):
        h = h + torch.einsum('btd,de->bte', xp[:, i * dil:i * dil + T, :], w[i])
    f, g = (h[..., :D].clone(), h[..., D:].clone())
    return torch.tanh(f) * _sigmoid(g)
```

```asm
; @launch grid=(256,1,1) block=(256,1,1) lds=139264
.amdgcn_target "amdgcn-amd-amdhsa--gfx950"
.text
.globl standalone__autoregressive_conv_wavernn__speech_kernel
.p2align 8
.type standalone__autoregressive_conv_wavernn__speech_kernel,@function
standalone__autoregressive_conv_wavernn__speech_kernel:
    s_cmp_ge_u32 s2, 256
    s_cbranch_scc1 L_end
    s_load_dwordx4 s[4:7], s[0:1], 0
    s_load_dwordx2 s[8:9], s[0:1], 16
    s_and_b32 s40, s2, 7
    s_lshr_b32 s43, s2, 3
    s_lshl_b32 s24, s40, 1
    s_and_b32 s40, s43, 1
    s_add_u32 s24, s24, s40
    s_lshr_b32 s25, s43, 1
    s_lshr_b32 s26, s25, 3
    s_and_b32 s25, s25, 7
    s_lshl_b32 s27, s25, 7
    s_lshl_b32 s28, s24, 5
    v_and_b32 v1, 63, v0
    v_lshrrev_b32 v2, 6, v0
    s_mov_b32 s30, 0x05040100
    v_readfirstlane_b32 s29, v2
    s_mov_b32 s31, 0x07060302
    s_mov_b32 s41, 0x4038aa3b
    s_mov_b32 s42, 0xbfb8aa3b
    s_mul_i32 s38, s29, 34816
    s_lshl_b32 s32, s29, 18
    s_lshl_b32 s40, s28, 1
    s_add_u32 s32, s32, s40
    v_lshrrev_b32 v3, 4, v1
    v_and_b32 v23, 15, v1
    v_lshlrev_b32 v14, 14, v3
    v_lshl_add_u32 v14, v23, 2, v14
    v_add_u32 v15, 2048, v14
    v_add_u32 v16, 4096, v14
    v_add_u32 v17, 6144, v14
    v_add_u32 v18, 8192, v14
    v_add_u32 v19, 10240, v14
    v_add_u32 v20, 12288, v14
    v_add_u32 v21, 14336, v14
    v_lshrrev_b32 v22, 3, v1
    s_sub_u32 s40, s27, 8
    v_add_u32 v22, s40, v22
    v_lshlrev_b32 v22, 10, v22
    v_lshlrev_b32 v27, 1, v3
    v_and_b32 v27, 6, v27
    v_and_b32 v28, 7, v1
    v_xor_b32 v27, v27, v28
    v_lshlrev_b32 v27, 4, v27
    s_lshl_b32 s40, s29, 8
    v_add3_u32 v22, v22, v27, s40
    s_cmp_eq_u32 s27, 0
    s_cselect_b32 s39, 0x40000000, 0
    v_lshlrev_b32 v27, 7, v23
    v_add_u32 v27, s38, v27
    v_lshrrev_b32 v28, 1, v23
    v_lshlrev_b32 v29, 4, v3
    v_add_u32 v30, 0, v28
    v_and_b32 v30, 3, v30
    v_lshlrev_b32 v30, 5, v30
    v_xor_b32 v30, v30, v29
    v_add_u32 v4, v27, v30
    v_xor_b32 v5, 64, v4
    v_add_u32 v30, 1, v28
    v_and_b32 v30, 3, v30
    v_lshlrev_b32 v30, 5, v30
    v_xor_b32 v30, v30, v29
    v_add_u32 v6, v27, v30
    v_add_u32 v6, 256, v6
    v_xor_b32 v7, 64, v6
    v_add_u32 v30, 2, v28
    v_and_b32 v30, 3, v30
    v_lshlrev_b32 v30, 5, v30
    v_xor_b32 v30, v30, v29
    v_add_u32 v8, v27, v30
    v_add_u32 v8, 512, v8
    v_xor_b32 v9, 64, v8
    v_add_u32 v30, 3, v28
    v_and_b32 v30, 3, v30
    v_lshlrev_b32 v30, 5, v30
    v_xor_b32 v30, v30, v29
    v_add_u32 v10, v27, v30
    v_add_u32 v10, 768, v10
    v_xor_b32 v11, 64, v10
    v_add_u32 v30, 4, v28
    v_and_b32 v30, 3, v30
    v_lshlrev_b32 v30, 5, v30
    v_xor_b32 v30, v30, v29
    v_add_u32 v12, v27, v30
    v_add_u32 v12, 1024, v12
    v_xor_b32 v13, 64, v12
    v_lshlrev_b32 v26, 4, v1
    v_lshlrev_b32 v25, 2, v3
    v_add_u32 v25, s27, v25
    v_lshlrev_b32 v25, 10, v25
    v_lshlrev_b32 v27, 2, v23
    s_lshl_b32 s40, s28, 1
    v_add3_u32 v25, v25, v27, s40
    s_waitcnt lgkmcnt(0)
    s_mul_i32 s40, s26, 1024000
    s_add_u32 s12, s4, s40
    s_addc_u32 s13, s5, 0
    s_and_b32 s13, s13, 0xffff
    s_mov_b32 s14, 1024000
    s_mov_b32 s15, 0x00020000
    s_mov_b32 s16, s6
    s_and_b32 s17, s7, 0xffff
    s_mov_b32 s18, 5242880
    s_mov_b32 s19, 0x00020000
    s_add_u32 s20, s8, s40
    s_addc_u32 s21, s9, 0
    s_and_b32 s21, s21, 0xffff
    s_mov_b32 s22, 1024000
    s_mov_b32 s23, 0x00020000
    s_lshr_b32 s45, s2, 3
    s_lshl_b32 s44, s29, 5
    s_add_u32 s44, s44, s45
    s_cmp_ge_u32 s44, 80
    s_cbranch_scc1 L_nopf
    s_lshr_b32 s45, s44, 1
    s_lshl_b32 s45, s45, 17
    s_and_b32 s46, s44, 1
    s_lshl_b32 s46, s46, 10
    s_add_u32 s45, s45, s46
    s_and_b32 s46, s24, 14
    s_lshl_b32 s46, s46, 6
    s_add_u32 s45, s45, s46
    v_lshlrev_b32 v177, 11, v1
    buffer_load_dword v176, v177, s[16:19], s45 offen
L_nopf:
    s_add_u32 s33, s32, 0
    buffer_load_dword v96, v14, s[16:19], s33 offen
    buffer_load_dword v97, v15, s[16:19], s33 offen
    buffer_load_dword v98, v16, s[16:19], s33 offen
    buffer_load_dword v99, v17, s[16:19], s33 offen
    buffer_load_dword v100, v18, s[16:19], s33 offen
    buffer_load_dword v101, v19, s[16:19], s33 offen
    buffer_load_dword v102, v20, s[16:19], s33 offen
    buffer_load_dword v103, v21, s[16:19], s33 offen
    buffer_load_dword v104, v14, s[16:19], s33 offen offset:1024
    buffer_load_dword v105, v15, s[16:19], s33 offen offset:1024
    buffer_load_dword v106, v16, s[16:19], s33 offen offset:1024
    buffer_load_dword v107, v17, s[16:19], s33 offen offset:1024
    buffer_load_dword v108, v18, s[16:19], s33 offen offset:1024
    buffer_load_dword v109, v19, s[16:19], s33 offen offset:1024
    buffer_load_dword v110, v20, s[16:19], s33 offen offset:1024
    buffer_load_dword v111, v21, s[16:19], s33 offen offset:1024
    s_add_u32 m0, s38, 0
    s_add_u32 s40, s39, 0
    v_add_u32 v24, s40, v22
    buffer_load_dwordx4 v24, s[12:15], 0 offen lds
    s_add_u32 m0, s38, 1024
    v_add_u32 v24, 8192, v22
    buffer_load_dwordx4 v24, s[12:15], 0 offen lds
    s_add_u32 m0, s38, 2048
    v_add_u32 v24, 16384, v22
    buffer_load_dwordx4 v24, s[12:15], 0 offen lds
    s_add_u32 m0, s38, 3072
    v_add_u32 v24, 24576, v22
    buffer_load_dwordx4 v24, s[12:15], 0 offen lds
    s_add_u32 m0, s38, 4096
    v_add_u32 v24, 32768, v22
    buffer_load_dwordx4 v24, s[12:15], 0 offen lds
    s_add_u32 m0, s38, 5120
    v_add_u32 v24, 40960, v22
    buffer_load_dwordx4 v24, s[12:15], 0 offen lds
    s_add_u32 m0, s38, 6144
    v_add_u32 v24, 49152, v22
    buffer_load_dwordx4 v24, s[12:15], 0 offen lds
    s_add_u32 m0, s38, 7168
    v_add_u32 v24, 57344, v22
    buffer_load_dwordx4 v24, s[12:15], 0 offen lds
    s_add_u32 m0, s38, 8192
    v_add_u32 v24, 65536, v22
    buffer_load_dwordx4 v24, s[12:15], 0 offen lds
    s_add_u32 m0, s38, 9216
    v_add_u32 v24, 73728, v22
    buffer_load_dwordx4 v24, s[12:15], 0 offen lds
    s_add_u32 m0, s38, 10240
    v_add_u32 v24, 81920, v22
    buffer_load_dwordx4 v24, s[12:15], 0 offen lds
    s_add_u32 m0, s38, 11264
    v_add_u32 v24, 90112, v22
    buffer_load_dwordx4 v24, s[12:15], 0 offen lds
    s_add_u32 m0, s38, 12288
    v_add_u32 v24, 98304, v22
    buffer_load_dwordx4 v24, s[12:15], 0 offen lds
    s_add_u32 m0, s38, 13312
    v_add_u32 v24, 106496, v22
    buffer_load_dwordx4 v24, s[12:15], 0 offen lds
    s_add_u32 m0, s38, 14336
    v_add_u32 v24, 114688, v22
    buffer_load_dwordx4 v24, s[12:15], 0 offen lds
    s_add_u32 m0, s38, 15360
    v_add_u32 v24, 122880, v22
    buffer_load_dwordx4 v24, s[12:15], 0 offen lds
    s_add_u32 m0, s38, 16384
    v_add_u32 v24, 131072, v22
    buffer_load_dwordx4 v24, s[12:15], 0 offen lds
    s_add_u32 s34, s32, 65536
    buffer_load_dword v112, v14, s[16:19], s34 offen
    buffer_load_dword v113, v15, s[16:19], s34 offen
    buffer_load_dword v114, v16, s[16:19], s34 offen
    buffer_load_dword v115, v17, s[16:19], s34 offen
    buffer_load_dword v116, v18, s[16:19], s34 offen
    buffer_load_dword v117, v19, s[16:19], s34 offen
    buffer_load_dword v118, v20, s[16:19], s34 offen
    buffer_load_dword v119, v21, s[16:19], s34 offen
    buffer_load_dword v120, v14, s[16:19], s34 offen offset:1024
    buffer_load_dword v121, v15, s[16:19], s34 offen offset:1024
    buffer_load_dword v122, v16, s[16:19], s34 offen offset:1024
    buffer_load_dword v123, v17, s[16:19], s34 offen offset:1024
    buffer_load_dword v124, v18, s[16:19], s34 offen offset:1024
    buffer_load_dword v125, v19, s[16:19], s34 offen offset:1024
    buffer_load_dword v126, v20, s[16:19], s34 offen offset:1024
    buffer_load_dword v127, v21, s[16:19], s34 offen offset:1024
    s_waitcnt vmcnt(16)
    v_perm_b32 v144, v97, v96, s30
    v_perm_b32 v148, v97, v96, s31
    v_perm_b32 v145, v99, v98, s30
    v_perm_b32 v149, v99, v98, s31
    v_perm_b32 v146, v101, v100, s30
    v_perm_b32 v150, v101, v100, s31
    v_perm_b32 v147, v103, v102, s30
    v_perm_b32 v151, v103, v102, s31
    v_perm_b32 v152, v105, v104, s30
    v_perm_b32 v156, v105, v104, s31
    v_perm_b32 v153, v107, v106, s30
    v_perm_b32 v157, v107, v106, s31
    v_perm_b32 v154, v109, v108, s30
    v_perm_b32 v158, v109, v108, s31
    v_perm_b32 v155, v111, v110, s30
    v_perm_b32 v159, v111, v110, s31
    ds_read_b128 v[32:35], v4 offset:0
    ds_read_b128 v[36:39], v4 offset:2048
    ds_read_b128 v[40:43], v4 offset:4096
    ds_read_b128 v[44:47], v4 offset:6144
    ds_read_b128 v[48:51], v4 offset:8192
    ds_read_b128 v[52:55], v4 offset:10240
    ds_read_b128 v[56:59], v4 offset:12288
    ds_read_b128 v[60:63], v4 offset:14336
    s_add_u32 s35, s32, 1048576
    buffer_load_dword v128, v14, s[16:19], s35 offen
    buffer_load_dword v129, v15, s[16:19], s35 offen
    buffer_load_dword v130, v16, s[16:19], s35 offen
    buffer_load_dword v131, v17, s[16:19], s35 offen
    buffer_load_dword v132, v18, s[16:19], s35 offen
    buffer_load_dword v133, v19, s[16:19], s35 offen
    buffer_load_dword v134, v20, s[16:19], s35 offen
    buffer_load_dword v135, v21, s[16:19], s35 offen
    buffer_load_dword v136, v14, s[16:19], s35 offen offset:1024
    buffer_load_dword v137, v15, s[16:19], s35 offen offset:1024
    buffer_load_dword v138, v16, s[16:19], s35 offen offset:1024
    buffer_load_dword v139, v17, s[16:19], s35 offen offset:1024
    buffer_load_dword v140, v18, s[16:19], s35 offen offset:1024
    buffer_load_dword v141, v19, s[16:19], s35 offen offset:1024
    buffer_load_dword v142, v20, s[16:19], s35 offen offset:1024
    buffer_load_dword v143, v21, s[16:19], s35 offen offset:1024
    s_waitcnt lgkmcnt(0)
    v_mfma_f32_16x16x32_bf16 a[0:3], v[32:35], v[144:147], 0
    s_add_u32 s36, s32, 1114112
    buffer_load_dword v96, v14, s[16:19], s36 offen
    v_mfma_f32_16x16x32_bf16 a[4:7], v[32:35], v[148:151], 0
    buffer_load_dword v97, v15, s[16:19], s36 offen
    buffer_load_dword v98, v16, s[16:19], s36 offen
    v_mfma_f32_16x16x32_bf16 a[8:11], v[32:35], v[152:155], 0
    buffer_load_dword v99, v17, s[16:19], s36 offen
    buffer_load_dword v100, v18, s[16:19], s36 offen
    v_mfma_f32_16x16x32_bf16 a[12:15], v[32:35], v[156:159], 0
    buffer_load_dword v101, v19, s[16:19], s36 offen
    buffer_load_dword v102, v20, s[16:19], s36 offen
    v_mfma_f32_16x16x32_bf16 a[16:19], v[36:39], v[144:147], 0
    buffer_load_dword v103, v21, s[16:19], s36 offen
    buffer_load_dword v104, v14, s[16:19], s36 offen offset:1024
    v_mfma_f32_16x16x32_bf16 a[20:23], v[36:39], v[148:151], 0
    buffer_load_dword v105, v15, s[16:19], s36 offen offset:1024
    v_mfma_f32_16x16x32_bf16 a[24:27], v[36:39], v[152:155], 0
    buffer_load_dword v106, v16, s[16:19], s36 offen offset:1024
    buffer_load_dword v107, v17, s[16:19], s36 offen offset:1024
    v_mfma_f32_16x16x32_bf16 a[28:31], v[36:39], v[156:159], 0
    buffer_load_dword v108, v18, s[16:19], s36 offen offset:1024
    buffer_load_dword v109, v19, s[16:19], s36 offen offset:1024
    v_mfma_f32_16x16x32_bf16 a[32:35], v[40:43], v[144:147], 0
    buffer_load_dword v110, v20, s[16:19], s36 offen offset:1024
    buffer_load_dword v111, v21, s[16:19], s36 offen offset:1024
    v_mfma_f32_16x16x32_bf16 a[36:39], v[40:43], v[148:151], 0
    ds_read_b128 v[64:67], v5 offset:0
    ds_read_b128 v[68:71], v5 offset:2048
    v_mfma_f32_16x16x32_bf16 a[40:43], v[40:43], v[152:155], 0
    ds_read_b128 v[72:75], v5 offset:4096
    v_mfma_f32_16x16x32_bf16 a[44:47], v[40:43], v[156:159], 0
    ds_read_b128 v[76:79], v5 offset:6144
    ds_read_b128 v[80:83], v5 offset:8192
    v_mfma_f32_16x16x32_bf16 a[48:51], v[44:47], v[144:147], 0
    ds_read_b128 v[84:87], v5 offset:10240
    ds_read_b128 v[88:91], v5 offset:12288
    v_mfma_f32_16x16x32_bf16 a[52:55], v[44:47], v[148:151], 0
    ds_read_b128 v[92:95], v5 offset:14336
    s_waitcnt vmcnt(32)
    v_mfma_f32_16x16x32_bf16 a[56:59], v[44:47], v[152:155], 0
    v_perm_b32 v160, v113, v112, s30
    v_perm_b32 v164, v113, v112, s31
    v_mfma_f32_16x16x32_bf16 a[60:63], v[44:47], v[156:159], 0
    v_perm_b32 v161, v115, v114, s30
    v_mfma_f32_16x16x32_bf16 a[64:67], v[48:51], v[144:147], 0
    v_perm_b32 v165, v115, v114, s31
    v_perm_b32 v162, v117, v116, s30
    v_mfma_f32_16x16x32_bf16 a[68:71], v[48:51], v[148:151], 0
    v_perm_b32 v166, v117, v116, s31
    v_perm_b32 v163, v119, v118, s30
    v_mfma_f32_16x16x32_bf16 a[72:75], v[48:51], v[152:155], 0
    v_perm_b32 v167, v119, v118, s31
    v_perm_b32 v168, v121, v120, s30
    v_mfma_f32_16x16x32_bf16 a[76:79], v[48:51], v[156:159], 0
    v_perm_b32 v172, v121, v120, s31
    v_perm_b32 v169, v123, v122, s30
    v_mfma_f32_16x16x32_bf16 a[80:83], v[52:55], v[144:147], 0
    v_perm_b32 v173, v123, v122, s31
    v_perm_b32 v170, v125, v124, s30
    v_mfma_f32_16x16x32_bf16 a[84:87], v[52:55], v[148:151], 0
    v_perm_b32 v174, v125, v124, s31
    v_mfma_f32_16x16x32_bf16 a[88:91], v[52:55], v[152:155], 0
    v_perm_b32 v171, v127, v126, s30
    v_perm_b32 v175, v127, v126, s31
    v_mfma_f32_16x16x32_bf16 a[92:95], v[52:55], v[156:159], 0
    s_add_u32 m0, s38, 17408
    s_add_u32 s40, s39, 128
    v_mfma_f32_16x16x32_bf16 a[96:99], v[56:59], v[144:147], 0
    v_add_u32 v24, s40, v22
    buffer_load_dwordx4 v24, s[12:15], 0 offen lds
    v_mfma_f32_16x16x32_bf16 a[100:103], v[56:59], v[148:151], 0
    s_add_u32 m0, s38, 18432
    v_add_u32 v24, 8320, v22
    v_mfma_f32_16x16x32_bf16 a[104:107], v[56:59], v[152:155], 0
    buffer_load_dwordx4 v24, s[12:15], 0 offen lds
    v_mfma_f32_16x16x32_bf16 a[108:111], v[56:59], v[156:159], 0
    s_add_u32 m0, s38, 19456
    v_add_u32 v24, 16512, v22
    v_mfma_f32_16x16x32_bf16 a[112:115], v[60:63], v[144:147], 0
    buffer_load_dwordx4 v24, s[12:15], 0 offen lds
    s_add_u32 m0, s38, 20480
    v_mfma_f32_16x16x32_bf16 a[116:119], v[60:63], v[148:151], 0
    v_add_u32 v24, 24704, v22
    buffer_load_dwordx4 v24, s[12:15], 0 offen lds
    v_mfma_f32_16x16x32_bf16 a[120:123], v[60:63], v[152:155], 0
    s_add_u32 m0, s38, 21504
    v_add_u32 v24, 32896, v22
    v_mfma_f32_16x16x32_bf16 a[124:127], v[60:63], v[156:159], 0
    buffer_load_dwordx4 v24, s[12:15], 0 offen lds
    s_waitcnt lgkmcnt(0)
    v_mfma_f32_16x16x32_bf16 a[0:3], v[64:67], v[160:163], a[0:3]
    s_add_u32 s33, s32, 2097152
    buffer_load_dword v112, v14, s[16:19], s33 offen
    v_mfma_f32_16x16x32_bf16 a[4:7], v[64:67], v[164:167], a[4:7]
    buffer_load_dword v113, v15, s[16:19], s33 offen
    buffer_load_dword v114, v16, s[16:19], s33 offen
    v_mfma_f32_16x16x32_bf16 a[8:11], v[64:67], v[168:171], a[8:11]
    buffer_load_dword v115, v17, s[16:19], s33 offen
    buffer_load_dword v116, v18, s[16:19], s33 offen
    v_mfma_f32_16x16x32_bf16 a[12:15], v[64:67], v[172:175], a[12:15]
    buffer_load_dword v117, v19, s[16:19], s33 offen
    v_mfma_f32_16x16x32_bf16 a[16:19], v[68:71], v[160:163], a[16:19]
    buffer_load_dword v118, v20, s[16:19], s33 offen
    buffer_load_dword v119, v21, s[16:19], s33 offen
    v_mfma_f32_16x16x32_bf16 a[20:23], v[68:71], v[164:167], a[20:23]
    buffer_load_dword v120, v14, s[16:19], s33 offen offset:1024
    buffer_load_dword v121, v15, s[16:19], s33 offen offset:1024
    v_mfma_f32_16x16x32_bf16 a[24:27], v[68:71], v[168:171], a[24:27]
    buffer_load_dword v122, v16, s[16:19], s33 offen offset:1024
    v_mfma_f32_16x16x32_bf16 a[28:31], v[68:71], v[172:175], a[28:31]
    buffer_load_dword v123, v17, s[16:19], s33 offen offset:1024
    buffer_load_dword v124, v18, s[16:19], s33 offen offset:1024
    v_mfma_f32_16x16x32_bf16 a[32:35], v[72:75], v[160:163], a[32:35]
    buffer_load_dword v125, v19, s[16:19], s33 offen offset:1024
    buffer_load_dword v126, v20, s[16:19], s33 offen offset:1024
    v_mfma_f32_16x16x32_bf16 a[36:39], v[72:75], v[164:167], a[36:39]
    buffer_load_dword v127, v21, s[16:19], s33 offen offset:1024
    v_mfma_f32_16x16x32_bf16 a[40:43], v[72:75], v[168:171], a[40:43]
    ds_read_b128 v[32:35], v6 offset:0
    ds_read_b128 v[36:39], v6 offset:2048
    v_mfma_f32_16x16x32_bf16 a[44:47], v[72:75], v[172:175], a[44:47]
    ds_read_b128 v[40:43], v6 offset:4096
    ds_read_b128 v[44:47], v6 offset:6144
    v_mfma_f32_16x16x32_bf16 a[48:51], v[76:79], v[160:163], a[48:51]
    ds_read_b128 v[48:51], v6 offset:8192
    v_mfma_f32_16x16x32_bf16 a[52:55], v[76:79], v[164:167], a[52:55]
    ds_read_b128 v[52:55], v6 offset:10240
    ds_read_b128 v[56:59], v6 offset:12288
    v_mfma_f32_16x16x32_bf16 a[56:59], v[76:79], v[168:171], a[56:59]
    ds_read_b128 v[60:63], v6 offset:14336
    s_waitcnt vmcnt(37)
    v_mfma_f32_16x16x32_bf16 a[60:63], v[76:79], v[172:175], a[60:63]
    v_perm_b32 v144, v129, v128, s30
    v_mfma_f32_16x16x32_bf16 a[64:67], v[80:83], v[160:163], a[64:67]
    v_perm_b32 v148, v129, v128, s31
    v_perm_b32 v145, v131, v130, s30
    v_mfma_f32_16x16x32_bf16 a[68:71], v[80:83], v[164:167], a[68:71]
    v_perm_b32 v149, v131, v130, s31
    v_perm_b32 v146, v133, v132, s30
    v_mfma_f32_16x16x32_bf16 a[72:75], v[80:83], v[168:171], a[72:75]
    v_perm_b32 v150, v133, v132, s31
    v_perm_b32 v147, v135, v134, s30
    v_mfma_f32_16x16x32_bf16 a[76:79], v[80:83], v[172:175], a[76:79]
    v_perm_b32 v151, v135, v134, s31
    v_mfma_f32_16x16x32_bf16 a[80:83], v[84:87], v[160:163], a[80:83]
    v_perm_b32 v152, v137, v136, s30
    v_perm_b32 v156, v137, v136, s31
    v_mfma_f32_16x16x32_bf16 a[84:87], v[84:87], v[164:167], a[84:87]
    v_perm_b32 v153, v139, v138, s30
    v_perm_b32 v157, v139, v138, s31
    v_mfma_f32_16x16x32_bf16 a[88:91], v[84:87], v[168:171], a[88:91]
    v_perm_b32 v154, v141, v140, s30
    v_mfma_f32_16x16x32_bf16 a[92:95], v[84:87], v[172:175], a[92:95]
    v_perm_b32 v158, v141, v140, s31
    v_perm_b32 v155, v143, v142, s30
    v_mfma_f32_16x16x32_bf16 a[96:99], v[88:91], v[160:163], a[96:99]
    v_perm_b32 v159, v143, v142, s31
    s_add_u32 m0, s38, 22528
    v_mfma_f32_16x16x32_bf16 a[100:103], v[88:91], v[164:167], a[100:103]
    v_add_u32 v24, 41088, v22
    v_mfma_f32_16x16x32_bf16 a[104:107], v[88:91], v[168:171], a[104:107]
    buffer_load_dwordx4 v24, s[12:15], 0 offen lds
    s_add_u32 m0, s38, 23552
    v_mfma_f32_16x16x32_bf16 a[108:111], v[88:91], v[172:175], a[108:111]
    v_add_u32 v24, 49280, v22
    buffer_load_dwordx4 v24, s[12:15], 0 offen lds
    v_mfma_f32_16x16x32_bf16 a[112:115], v[92:95], v[160:163], a[112:115]
    s_add_u32 m0, s38, 24576
    v_mfma_f32_16x16x32_bf16 a[116:119], v[92:95], v[164:167], a[116:119]
    v_add_u32 v24, 57472, v22
    buffer_load_dwordx4 v24, s[12:15], 0 offen lds
    v_mfma_f32_16x16x32_bf16 a[120:123], v[92:95], v[168:171], a[120:123]
    s_add_u32 m0, s38, 25600
    v_add_u32 v24, 65664, v22
    v_mfma_f32_16x16x32_bf16 a[124:127], v[92:95], v[172:175], a[124:127]
    buffer_load_dwordx4 v24, s[12:15], 0 offen lds
    s_waitcnt lgkmcnt(0)
    v_mfma_f32_16x16x32_bf16 a[0:3], v[32:35], v[144:147], a[0:3]
    s_add_u32 s34, s32, 2162688
    buffer_load_dword v128, v14, s[16:19], s34 offen
    v_mfma_f32_16x16x32_bf16 a[4:7], v[32:35], v[148:151], a[4:7]
    buffer_load_dword v129, v15, s[16:19], s34 offen
    buffer_load_dword v130, v16, s[16:19], s34 offen
    v_mfma_f32_16x16x32_bf16 a[8:11], v[32:35], v[152:155], a[8:11]
    buffer_load_dword v131, v17, s[16:19], s34 offen
    buffer_load_dword v132, v18, s[16:19], s34 offen
    v_mfma_f32_16x16x32_bf16 a[12:15], v[32:35], v[156:159], a[12:15]
    buffer_load_dword v133, v19, s[16:19], s34 offen
    v_mfma_f32_16x16x32_bf16 a[16:19], v[36:39], v[144:147], a[16:19]
    buffer_load_dword v134, v20, s[16:19], s34 offen
    buffer_load_dword v135, v21, s[16:19], s34 offen
    v_mfma_f32_16x16x32_bf16 a[20:23], v[36:39], v[148:151], a[20:23]
    buffer_load_dword v136, v14, s[16:19], s34 offen offset:1024
    buffer_load_dword v137, v15, s[16:19], s34 offen offset:1024
    v_mfma_f32_16x16x32_bf16 a[24:27], v[36:39], v[152:155], a[24:27]
    buffer_load_dword v138, v16, s[16:19], s34 offen offset:1024
    v_mfma_f32_16x16x32_bf16 a[28:31], v[36:39], v[156:159], a[28:31]
    buffer_load_dword v139, v17, s[16:19], s34 offen offset:1024
    buffer_load_dword v140, v18, s[16:19], s34 offen offset:1024
    v_mfma_f32_16x16x32_bf16 a[32:35], v[40:43], v[144:147], a[32:35]
    buffer_load_dword v141, v19, s[16:19], s34 offen offset:1024
    buffer_load_dword v142, v20, s[16:19], s34 offen offset:1024
    v_mfma_f32_16x16x32_bf16 a[36:39], v[40:43], v[148:151], a[36:39]
    buffer_load_dword v143, v21, s[16:19], s34 offen offset:1024
    v_mfma_f32_16x16x32_bf16 a[40:43], v[40:43], v[152:155], a[40:43]
    ds_read_b128 v[64:67], v7 offset:0
    ds_read_b128 v[68:71], v7 offset:2048
    v_mfma_f32_16x16x32_bf16 a[44:47], v[40:43], v[156:159], a[44:47]
    ds_read_b128 v[72:75], v7 offset:4096
    ds_read_b128 v[76:79], v7 offset:6144
    v_mfma_f32_16x16x32_bf16 a[48:51], v[44:47], v[144:147], a[48:51]
    ds_read_b128 v[80:83], v7 offset:8192
    v_mfma_f32_16x16x32_bf16 a[52:55], v[44:47], v[148:151], a[52:55]
    ds_read_b128 v[84:87], v7 offset:10240
    ds_read_b128 v[88:91], v7 offset:12288
    v_mfma_f32_16x16x32_bf16 a[56:59], v[44:47], v[152:155], a[56:59]
    ds_read_b128 v[92:95], v7 offset:14336
    s_waitcnt vmcnt(41)
    v_mfma_f32_16x16x32_bf16 a[60:63], v[44:47], v[156:159], a[60:63]
    v_perm_b32 v160, v97, v96, s30
    v_mfma_f32_16x16x32_bf16 a[64:67], v[48:51], v[144:147], a[64:67]
    v_perm_b32 v164, v97, v96, s31
    v_perm_b32 v161, v99, v98, s30
    v_mfma_f32_16x16x32_bf16 a[68:71], v[48:51], v[148:151], a[68:71]
    v_perm_b32 v165, v99, v98, s31
    v_perm_b32 v162, v101, v100, s30
    v_mfma_f32_16x16x32_bf16 a[72:75], v[48:51], v[152:155], a[72:75]
    v_perm_b32 v166, v101, v100, s31
    v_perm_b32 v163, v103, v102, s30
    v_mfma_f32_16x16x32_bf16 a[76:79], v[48:51], v[156:159], a[76:79]
    v_perm_b32 v167, v103, v102, s31
    v_mfma_f32_16x16x32_bf16 a[80:83], v[52:55], v[144:147], a[80:83]
    v_perm_b32 v168, v105, v104, s30
    v_perm_b32 v172, v105, v104, s31
    v_mfma_f32_16x16x32_bf16 a[84:87], v[52:55], v[148:151], a[84:87]
    v_perm_b32 v169, v107, v106, s30
    v_perm_b32 v173, v107, v106, s31
    v_mfma_f32_16x16x32_bf16 a[88:91], v[52:55], v[152:155], a[88:91]
    v_perm_b32 v170, v109, v108, s30
    v_mfma_f32_16x16x32_bf16 a[92:95], v[52:55], v[156:159], a[92:95]
    v_perm_b32 v174, v109, v108, s31
    v_perm_b32 v171, v111, v110, s30
    v_mfma_f32_16x16x32_bf16 a[96:99], v[56:59], v[144:147], a[96:99]
    v_perm_b32 v175, v111, v110, s31
    s_add_u32 m0, s38, 26624
    v_mfma_f32_16x16x32_bf16 a[100:103], v[56:59], v[148:151], a[100:103]
    v_add_u32 v24, 73856, v22
    v_mfma_f32_16x16x32_bf16 a[104:107], v[56:59], v[152:155], a[104:107]
    buffer_load_dwordx4 v24, s[12:15], 0 offen lds
    s_add_u32 m0, s38, 27648
    v_mfma_f32_16x16x32_bf16 a[108:111], v[56:59], v[156:159], a[108:111]
    v_add_u32 v24, 82048, v22
    buffer_load_dwordx4 v24, s[12:15], 0 offen lds
    v_mfma_f32_16x16x32_bf16 a[112:115], v[60:63], v[144:147], a[112:115]
    s_add_u32 m0, s38, 28672
    v_mfma_f32_16x16x32_bf16 a[116:119], v[60:63], v[148:151], a[116:119]
    v_add_u32 v24, 90240, v22
    buffer_load_dwordx4 v24, s[12:15], 0 offen lds
    v_mfma_f32_16x16x32_bf16 a[120:123], v[60:63], v[152:155], a[120:123]
    s_add_u32 m0, s38, 29696
    v_add_u32 v24, 98432, v22
    v_mfma_f32_16x16x32_bf16 a[124:127], v[60:63], v[156:159], a[124:127]
    buffer_load_dwordx4 v24, s[12:15], 0 offen lds
    s_waitcnt lgkmcnt(0)
    v_mfma_f32_16x16x32_bf16 a[0:3], v[64:67], v[160:163], a[0:3]
    s_add_u32 s35, s32, 3145728
    buffer_load_dword v96, v14, s[16:19], s35 offen
    v_mfma_f32_16x16x32_bf16 a[4:7], v[64:67], v[164:167], a[4:7]
    buffer_load_dword v97, v15, s[16:19], s35 offen
    buffer_load_dword v98, v16, s[16:19], s35 offen
    v_mfma_f32_16x16x32_bf16 a[8:11], v[64:67], v[168:171], a[8:11]
    buffer_load_dword v99, v17, s[16:19], s35 offen
    buffer_load_dword v100, v18, s[16:19], s35 offen
    v_mfma_f32_16x16x32_bf16 a[12:15], v[64:67], v[172:175], a[12:15]
    buffer_load_dword v101, v19, s[16:19], s35 offen
    v_mfma_f32_16x16x32_bf16 a[16:19], v[68:71], v[160:163], a[16:19]
    buffer_load_dword v102, v20, s[16:19], s35 offen
    buffer_load_dword v103, v21, s[16:19], s35 offen
    v_mfma_f32_16x16x32_bf16 a[20:23], v[68:71], v[164:167], a[20:23]
    buffer_load_dword v104, v14, s[16:19], s35 offen offset:1024
    buffer_load_dword v105, v15, s[16:19], s35 offen offset:1024
    v_mfma_f32_16x16x32_bf16 a[24:27], v[68:71], v[168:171], a[24:27]
    buffer_load_dword v106, v16, s[16:19], s35 offen offset:1024
    v_mfma_f32_16x16x32_bf16 a[28:31], v[68:71], v[172:175], a[28:31]
    buffer_load_dword v107, v17, s[16:19], s35 offen offset:1024
    buffer_load_dword v108, v18, s[16:19], s35 offen offset:1024
    v_mfma_f32_16x16x32_bf16 a[32:35], v[72:75], v[160:163], a[32:35]
    buffer_load_dword v109, v19, s[16:19], s35 offen offset:1024
    buffer_load_dword v110, v20, s[16:19], s35 offen offset:1024
    v_mfma_f32_16x16x32_bf16 a[36:39], v[72:75], v[164:167], a[36:39]
    buffer_load_dword v111, v21, s[16:19], s35 offen offset:1024
    v_mfma_f32_16x16x32_bf16 a[40:43], v[72:75], v[168:171], a[40:43]
    ds_read_b128 v[32:35], v8 offset:0
    ds_read_b128 v[36:39], v8 offset:2048
    v_mfma_f32_16x16x32_bf16 a[44:47], v[72:75], v[172:175], a[44:47]
    ds_read_b128 v[40:43], v8 offset:4096
    ds_read_b128 v[44:47], v8 offset:6144
    v_mfma_f32_16x16x32_bf16 a[48:51], v[76:79], v[160:163], a[48:51]
    ds_read_b128 v[48:51], v8 offset:8192
    v_mfma_f32_16x16x32_bf16 a[52:55], v[76:79], v[164:167], a[52:55]
    ds_read_b128 v[52:55], v8 offset:10240
    ds_read_b128 v[56:59], v8 offset:12288
    v_mfma_f32_16x16x32_bf16 a[56:59], v[76:79], v[168:171], a[56:59]
    ds_read_b128 v[60:63], v8 offset:14336
    s_waitcnt vmcnt(40)
    v_mfma_f32_16x16x32_bf16 a[60:63], v[76:79], v[172:175], a[60:63]
    v_perm_b32 v144, v113, v112, s30
    v_mfma_f32_16x16x32_bf16 a[64:67], v[80:83], v[160:163], a[64:67]
    v_perm_b32 v148, v113, v112, s31
    v_perm_b32 v145, v115, v114, s30
    v_mfma_f32_16x16x32_bf16 a[68:71], v[80:83], v[164:167], a[68:71]
    v_perm_b32 v149, v115, v114, s31
    v_perm_b32 v146, v117, v116, s30
    v_mfma_f32_16x16x32_bf16 a[72:75], v[80:83], v[168:171], a[72:75]
    v_perm_b32 v150, v117, v116, s31
    v_perm_b32 v147, v119, v118, s30
    v_mfma_f32_16x16x32_bf16 a[76:79], v[80:83], v[172:175], a[76:79]
    v_perm_b32 v151, v119, v118, s31
    v_mfma_f32_16x16x32_bf16 a[80:83], v[84:87], v[160:163], a[80:83]
    v_perm_b32 v152, v121, v120, s30
    v_perm_b32 v156, v121, v120, s31
    v_mfma_f32_16x16x32_bf16 a[84:87], v[84:87], v[164:167], a[84:87]
    v_perm_b32 v153, v123, v122, s30
    v_perm_b32 v157, v123, v122, s31
    v_mfma_f32_16x16x32_bf16 a[88:91], v[84:87], v[168:171], a[88:91]
    v_perm_b32 v154, v125, v124, s30
    v_mfma_f32_16x16x32_bf16 a[92:95], v[84:87], v[172:175], a[92:95]
    v_perm_b32 v158, v125, v124, s31
    v_perm_b32 v155, v127, v126, s30
    v_mfma_f32_16x16x32_bf16 a[96:99], v[88:91], v[160:163], a[96:99]
    v_perm_b32 v159, v127, v126, s31
    s_add_u32 m0, s38, 30720
    v_mfma_f32_16x16x32_bf16 a[100:103], v[88:91], v[164:167], a[100:103]
    v_add_u32 v24, 106624, v22
    v_mfma_f32_16x16x32_bf16 a[104:107], v[88:91], v[168:171], a[104:107]
    buffer_load_dwordx4 v24, s[12:15], 0 offen lds
    s_add_u32 m0, s38, 31744
    v_mfma_f32_16x16x32_bf16 a[108:111], v[88:91], v[172:175], a[108:111]
    v_add_u32 v24, 114816, v22
    buffer_load_dwordx4 v24, s[12:15], 0 offen lds
    v_mfma_f32_16x16x32_bf16 a[112:115], v[92:95], v[160:163], a[112:115]
    s_add_u32 m0, s38, 32768
    v_mfma_f32_16x16x32_bf16 a[116:119], v[92:95], v[164:167], a[116:119]
    v_add_u32 v24, 123008, v22
    buffer_load_dwordx4 v24, s[12:15], 0 offen lds
    v_mfma_f32_16x16x32_bf16 a[120:123], v[92:95], v[168:171], a[120:123]
    s_add_u32 m0, s38, 33792
    v_add_u32 v24, 131200, v22
    v_mfma_f32_16x16x32_bf16 a[124:127], v[92:95], v[172:175], a[124:127]
    buffer_load_dwordx4 v24, s[12:15], 0 offen lds
    s_waitcnt lgkmcnt(0)
    v_mfma_f32_16x16x32_bf16 a[0:3], v[32:35], v[144:147], a[0:3]
    s_add_u32 s36, s32, 3211264
    buffer_load_dword v112, v14, s[16:19], s36 offen
    v_mfma_f32_16x16x32_bf16 a[4:7], v[32:35], v[148:151], a[4:7]
    buffer_load_dword v113, v15, s[16:19], s36 offen
    v_mfma_f32_16x16x32_bf16 a[8:11], v[32:35], v[152:155], a[8:11]
    buffer_load_dword v114, v16, s[16:19], s36 offen
    v_mfma_f32_16x16x32_bf16 a[12:15], v[32:35], v[156:159], a[12:15]
    buffer_load_dword v115, v17, s[16:19], s36 offen
    buffer_load_dword v116, v18, s[16:19], s36 offen
    v_mfma_f32_16x16x32_bf16 a[16:19], v[36:39], v[144:147], a[16:19]
    buffer_load_dword v117, v19, s[16:19], s36 offen
    v_mfma_f32_16x16x32_bf16 a[20:23], v[36:39], v[148:151], a[20:23]
    buffer_load_dword v118, v20, s[16:19], s36 offen
    v_mfma_f32_16x16x32_bf16 a[24:27], v[36:39], v[152:155], a[24:27]
    buffer_load_dword v119, v21, s[16:19], s36 offen
    buffer_load_dword v120, v14, s[16:19], s36 offen offset:1024
    v_mfma_f32_16x16x32_bf16 a[28:31], v[36:39], v[156:159], a[28:31]
    buffer_load_dword v121, v15, s[16:19], s36 offen offset:1024
    v_mfma_f32_16x16x32_bf16 a[32:35], v[40:43], v[144:147], a[32:35]
    buffer_load_dword v122, v16, s[16:19], s36 offen offset:1024
    v_mfma_f32_16x16x32_bf16 a[36:39], v[40:43], v[148:151], a[36:39]
    buffer_load_dword v123, v17, s[16:19], s36 offen offset:1024
    buffer_load_dword v124, v18, s[16:19], s36 offen offset:1024
    v_mfma_f32_16x16x32_bf16 a[40:43], v[40:43], v[152:155], a[40:43]
    buffer_load_dword v125, v19, s[16:19], s36 offen offset:1024
    v_mfma_f32_16x16x32_bf16 a[44:47], v[40:43], v[156:159], a[44:47]
    buffer_load_dword v126, v20, s[16:19], s36 offen offset:1024
    v_mfma_f32_16x16x32_bf16 a[48:51], v[44:47], v[144:147], a[48:51]
    buffer_load_dword v127, v21, s[16:19], s36 offen offset:1024
    ds_read_b128 v[64:67], v9 offset:0
    v_mfma_f32_16x16x32_bf16 a[52:55], v[44:47], v[148:151], a[52:55]
    ds_read_b128 v[68:71], v9 offset:2048
    v_mfma_f32_16x16x32_bf16 a[56:59], v[44:47], v[152:155], a[56:59]
    ds_read_b128 v[72:75], v9 offset:4096
    v_mfma_f32_16x16x32_bf16 a[60:63], v[44:47], v[156:159], a[60:63]
    ds_read_b128 v[76:79], v9 offset:6144
    v_mfma_f32_16x16x32_bf16 a[64:67], v[48:51], v[144:147], a[64:67]
    ds_read_b128 v[80:83], v9 offset:8192
    ds_read_b128 v[84:87], v9 offset:10240
    v_mfma_f32_16x16x32_bf16 a[68:71], v[48:51], v[148:151], a[68:71]
    ds_read_b128 v[88:91], v9 offset:12288
    v_mfma_f32_16x16x32_bf16 a[72:75], v[48:51], v[152:155], a[72:75]
    ds_read_b128 v[92:95], v9 offset:14336
    v_mfma_f32_16x16x32_bf16 a[76:79], v[48:51], v[156:159], a[76:79]
    s_waitcnt vmcnt(40)
    v_perm_b32 v160, v129, v128, s30
    v_mfma_f32_16x16x32_bf16 a[80:83], v[52:55], v[144:147], a[80:83]
    v_perm_b32 v164, v129, v128, s31
    v_mfma_f32_16x16x32_bf16 a[84:87], v[52:55], v[148:151], a[84:87]
    v_perm_b32 v161, v131, v130, s30
    v_mfma_f32_16x16x32_bf16 a[88:91], v[52:55], v[152:155], a[88:91]
    v_perm_b32 v165, v131, v130, s31
    v_perm_b32 v162, v133, v132, s30
    v_mfma_f32_16x16x32_bf16 a[92:95], v[52:55], v[156:159], a[92:95]
    v_perm_b32 v166, v133, v132, s31
    v_mfma_f32_16x16x32_bf16 a[96:99], v[56:59], v[144:147], a[96:99]
    v_perm_b32 v163, v135, v134, s30
    v_mfma_f32_16x16x32_bf16 a[100:103], v[56:59], v[148:151], a[100:103]
    v_perm_b32 v167, v135, v134, s31
    v_perm_b32 v168, v137, v136, s30
    v_mfma_f32_16x16x32_bf16 a[104:107], v[56:59], v[152:155], a[104:107]
    v_perm_b32 v172, v137, v136, s31
    v_mfma_f32_16x16x32_bf16 a[108:111], v[56:59], v[156:159], a[108:111]
    v_perm_b32 v169, v139, v138, s30
    v_mfma_f32_16x16x32_bf16 a[112:115], v[60:63], v[144:147], a[112:115]
    v_perm_b32 v173, v139, v138, s31
    v_perm_b32 v170, v141, v140, s30
    v_mfma_f32_16x16x32_bf16 a[116:119], v[60:63], v[148:151], a[116:119]
    v_perm_b32 v174, v141, v140, s31
    v_mfma_f32_16x16x32_bf16 a[120:123], v[60:63], v[152:155], a[120:123]
    v_perm_b32 v171, v143, v142, s30
    v_mfma_f32_16x16x32_bf16 a[124:127], v[60:63], v[156:159], a[124:127]
    v_perm_b32 v175, v143, v142, s31
    s_waitcnt lgkmcnt(0)
    v_mfma_f32_16x16x32_bf16 a[0:3], v[64:67], v[160:163], a[0:3]
    s_add_u32 s33, s32, 4194304
    buffer_load_dword v128, v14, s[16:19], s33 offen
    v_mfma_f32_16x16x32_bf16 a[4:7], v[64:67], v[164:167], a[4:7]
    buffer_load_dword v129, v15, s[16:19], s33 offen
    v_mfma_f32_16x16x32_bf16 a[8:11], v[64:67], v[168:171], a[8:11]
    buffer_load_dword v130, v16, s[16:19], s33 offen
    v_mfma_f32_16x16x32_bf16 a[12:15], v[64:67], v[172:175], a[12:15]
    buffer_load_dword v131, v17, s[16:19], s33 offen
    buffer_load_dword v132, v18, s[16:19], s33 offen
    v_mfma_f32_16x16x32_bf16 a[16:19], v[68:71], v[160:163], a[16:19]
    buffer_load_dword v133, v19, s[16:19], s33 offen
    v_mfma_f32_16x16x32_bf16 a[20:23], v[68:71], v[164:167], a[20:23]
    buffer_load_dword v134, v20, s[16:19], s33 offen
    v_mfma_f32_16x16x32_bf16 a[24:27], v[68:71], v[168:171], a[24:27]
    buffer_load_dword v135, v21, s[16:19], s33 offen
    buffer_load_dword v136, v14, s[16:19], s33 offen offset:1024
    v_mfma_f32_16x16x32_bf16 a[28:31], v[68:71], v[172:175], a[28:31]
    buffer_load_dword v137, v15, s[16:19], s33 offen offset:1024
    v_mfma_f32_16x16x32_bf16 a[32:35], v[72:75], v[160:163], a[32:35]
    buffer_load_dword v138, v16, s[16:19], s33 offen offset:1024
    v_mfma_f32_16x16x32_bf16 a[36:39], v[72:75], v[164:167], a[36:39]
    buffer_load_dword v139, v17, s[16:19], s33 offen offset:1024
    buffer_load_dword v140, v18, s[16:19], s33 offen offset:1024
    v_mfma_f32_16x16x32_bf16 a[40:43], v[72:75], v[168:171], a[40:43]
    buffer_load_dword v141, v19, s[16:19], s33 offen offset:1024
    v_mfma_f32_16x16x32_bf16 a[44:47], v[72:75], v[172:175], a[44:47]
    buffer_load_dword v142, v20, s[16:19], s33 offen offset:1024
    v_mfma_f32_16x16x32_bf16 a[48:51], v[76:79], v[160:163], a[48:51]
    buffer_load_dword v143, v21, s[16:19], s33 offen offset:1024
    ds_read_b128 v[32:35], v10 offset:0
    v_mfma_f32_16x16x32_bf16 a[52:55], v[76:79], v[164:167], a[52:55]
    ds_read_b128 v[36:39], v10 offset:2048
    v_mfma_f32_16x16x32_bf16 a[56:59], v[76:79], v[168:171], a[56:59]
    ds_read_b128 v[40:43], v10 offset:4096
    v_mfma_f32_16x16x32_bf16 a[60:63], v[76:79], v[172:175], a[60:63]
    ds_read_b128 v[44:47], v10 offset:6144
    v_mfma_f32_16x16x32_bf16 a[64:67], v[80:83], v[160:163], a[64:67]
    ds_read_b128 v[48:51], v10 offset:8192
    ds_read_b128 v[52:55], v10 offset:10240
    v_mfma_f32_16x16x32_bf16 a[68:71], v[80:83], v[164:167], a[68:71]
    ds_read_b128 v[56:59], v10 offset:12288
    v_mfma_f32_16x16x32_bf16 a[72:75], v[80:83], v[168:171], a[72:75]
    ds_read_b128 v[60:63], v10 offset:14336
    v_mfma_f32_16x16x32_bf16 a[76:79], v[80:83], v[172:175], a[76:79]
    s_waitcnt vmcnt(36)
    v_perm_b32 v144, v97, v96, s30
    v_mfma_f32_16x16x32_bf16 a[80:83], v[84:87], v[160:163], a[80:83]
    v_perm_b32 v148, v97, v96, s31
    v_mfma_f32_16x16x32_bf16 a[84:87], v[84:87], v[164:167], a[84:87]
    v_perm_b32 v145, v99, v98, s30
    v_mfma_f32_16x16x32_bf16 a[88:91], v[84:87], v[168:171], a[88:91]
    v_perm_b32 v149, v99, v98, s31
    v_perm_b32 v146, v101, v100, s30
    v_mfma_f32_16x16x32_bf16 a[92:95], v[84:87], v[172:175], a[92:95]
    v_perm_b32 v150, v101, v100, s31
    v_mfma_f32_16x16x32_bf16 a[96:99], v[88:91], v[160:163], a[96:99]
    v_perm_b32 v147, v103, v102, s30
    v_mfma_f32_16x16x32_bf16 a[100:103], v[88:91], v[164:167], a[100:103]
    v_perm_b32 v151, v103, v102, s31
    v_perm_b32 v152, v105, v104, s30
    v_mfma_f32_16x16x32_bf16 a[104:107], v[88:91], v[168:171], a[104:107]
    v_perm_b32 v156, v105, v104, s31
    v_mfma_f32_16x16x32_bf16 a[108:111], v[88:91], v[172:175], a[108:111]
    v_perm_b32 v153, v107, v106, s30
    v_mfma_f32_16x16x32_bf16 a[112:115], v[92:95], v[160:163], a[112:115]
    v_perm_b32 v157, v107, v106, s31
    v_perm_b32 v154, v109, v108, s30
    v_mfma_f32_16x16x32_bf16 a[116:119], v[92:95], v[164:167], a[116:119]
    v_perm_b32 v158, v109, v108, s31
    v_mfma_f32_16x16x32_bf16 a[120:123], v[92:95], v[168:171], a[120:123]
    v_perm_b32 v155, v111, v110, s30
    v_mfma_f32_16x16x32_bf16 a[124:127], v[92:95], v[172:175], a[124:127]
    v_perm_b32 v159, v111, v110, s31
    s_waitcnt lgkmcnt(0)
    v_mfma_f32_16x16x32_bf16 a[0:3], v[32:35], v[144:147], a[0:3]
    s_add_u32 s34, s32, 4259840
    buffer_load_dword v96, v14, s[16:19], s34 offen
    v_mfma_f32_16x16x32_bf16 a[4:7], v[32:35], v[148:151], a[4:7]
    buffer_load_dword v97, v15, s[16:19], s34 offen
    v_mfma_f32_16x16x32_bf16 a[8:11], v[32:35], v[152:155], a[8:11]
    buffer_load_dword v98, v16, s[16:19], s34 offen
    v_mfma_f32_16x16x32_bf16 a[12:15], v[32:35], v[156:159], a[12:15]
    buffer_load_dword v99, v17, s[16:19], s34 offen
    buffer_load_dword v100, v18, s[16:19], s34 offen
    v_mfma_f32_16x16x32_bf16 a[16:19], v[36:39], v[144:147], a[16:19]
    buffer_load_dword v101, v19, s[16:19], s34 offen
    v_mfma_f32_16x16x32_bf16 a[20:23], v[36:39], v[148:151], a[20:23]
    buffer_load_dword v102, v20, s[16:19], s34 offen
    v_mfma_f32_16x16x32_bf16 a[24:27], v[36:39], v[152:155], a[24:27]
    buffer_load_dword v103, v21, s[16:19], s34 offen
    buffer_load_dword v104, v14, s[16:19], s34 offen offset:1024
    v_mfma_f32_16x16x32_bf16 a[28:31], v[36:39], v[156:159], a[28:31]
    buffer_load_dword v105, v15, s[16:19], s34 offen offset:1024
    v_mfma_f32_16x16x32_bf16 a[32:35], v[40:43], v[144:147], a[32:35]
    buffer_load_dword v106, v16, s[16:19], s34 offen offset:1024
    v_mfma_f32_16x16x32_bf16 a[36:39], v[40:43], v[148:151], a[36:39]
    buffer_load_dword v107, v17, s[16:19], s34 offen offset:1024
    buffer_load_dword v108, v18, s[16:19], s34 offen offset:1024
    v_mfma_f32_16x16x32_bf16 a[40:43], v[40:43], v[152:155], a[40:43]
    buffer_load_dword v109, v19, s[16:19], s34 offen offset:1024
    v_mfma_f32_16x16x32_bf16 a[44:47], v[40:43], v[156:159], a[44:47]
    buffer_load_dword v110, v20, s[16:19], s34 offen offset:1024
    v_mfma_f32_16x16x32_bf16 a[48:51], v[44:47], v[144:147], a[48:51]
    buffer_load_dword v111, v21, s[16:19], s34 offen offset:1024
    ds_read_b128 v[64:67], v11 offset:0
    v_mfma_f32_16x16x32_bf16 a[52:55], v[44:47], v[148:151], a[52:55]
    ds_read_b128 v[68:71], v11 offset:2048
    v_mfma_f32_16x16x32_bf16 a[56:59], v[44:47], v[152:155], a[56:59]
    ds_read_b128 v[72:75], v11 offset:4096
    v_mfma_f32_16x16x32_bf16 a[60:63], v[44:47], v[156:159], a[60:63]
    ds_read_b128 v[76:79], v11 offset:6144
    v_mfma_f32_16x16x32_bf16 a[64:67], v[48:51], v[144:147], a[64:67]
    ds_read_b128 v[80:83], v11 offset:8192
    ds_read_b128 v[84:87], v11 offset:10240
    v_mfma_f32_16x16x32_bf16 a[68:71], v[48:51], v[148:151], a[68:71]
    ds_read_b128 v[88:91], v11 offset:12288
    v_mfma_f32_16x16x32_bf16 a[72:75], v[48:51], v[152:155], a[72:75]
    ds_read_b128 v[92:95], v11 offset:14336
    v_mfma_f32_16x16x32_bf16 a[76:79], v[48:51], v[156:159], a[76:79]
    s_waitcnt vmcnt(32)
    v_perm_b32 v160, v113, v112, s30
    v_mfma_f32_16x16x32_bf16 a[80:83], v[52:55], v[144:147], a[80:83]
    v_perm_b32 v164, v113, v112, s31
    v_mfma_f32_16x16x32_bf16 a[84:87], v[52:55], v[148:151], a[84:87]
    v_perm_b32 v161, v115, v114, s30
    v_mfma_f32_16x16x32_bf16 a[88:91], v[52:55], v[152:155], a[88:91]
    v_perm_b32 v165, v115, v114, s31
    v_perm_b32 v162, v117, v116, s30
    v_mfma_f32_16x16x32_bf16 a[92:95], v[52:55], v[156:159], a[92:95]
    v_perm_b32 v166, v117, v116, s31
    v_mfma_f32_16x16x32_bf16 a[96:99], v[56:59], v[144:147], a[96:99]
    v_perm_b32 v163, v119, v118, s30
    v_mfma_f32_16x16x32_bf16 a[100:103], v[56:59], v[148:151], a[100:103]
    v_perm_b32 v167, v119, v118, s31
    v_perm_b32 v168, v121, v120, s30
    v_mfma_f32_16x16x32_bf16 a[104:107], v[56:59], v[152:155], a[104:107]
    v_perm_b32 v172, v121, v120, s31
    v_mfma_f32_16x16x32_bf16 a[108:111], v[56:59], v[156:159], a[108:111]
    v_perm_b32 v169, v123, v122, s30
    v_mfma_f32_16x16x32_bf16 a[112:115], v[60:63], v[144:147], a[112:115]
    v_perm_b32 v173, v123, v122, s31
    v_perm_b32 v170, v125, v124, s30
    v_mfma_f32_16x16x32_bf16 a[116:119], v[60:63], v[148:151], a[116:119]
    v_perm_b32 v174, v125, v124, s31
    v_mfma_f32_16x16x32_bf16 a[120:123], v[60:63], v[152:155], a[120:123]
    v_perm_b32 v171, v127, v126, s30
    v_mfma_f32_16x16x32_bf16 a[124:127], v[60:63], v[156:159], a[124:127]
    v_perm_b32 v175, v127, v126, s31
    s_waitcnt lgkmcnt(0)
    v_mfma_f32_16x16x32_bf16 a[0:3], v[64:67], v[160:163], a[0:3]
    s_add_u32 s35, s32, 131072
    buffer_load_dword v112, v14, s[16:19], s35 offen
    v_mfma_f32_16x16x32_bf16 a[4:7], v[64:67], v[164:167], a[4:7]
    buffer_load_dword v113, v15, s[16:19], s35 offen
    v_mfma_f32_16x16x32_bf16 a[8:11], v[64:67], v[168:171], a[8:11]
    buffer_load_dword v114, v16, s[16:19], s35 offen
    v_mfma_f32_16x16x32_bf16 a[12:15], v[64:67], v[172:175], a[12:15]
    buffer_load_dword v115, v17, s[16:19], s35 offen
    buffer_load_dword v116, v18, s[16:19], s35 offen
    v_mfma_f32_16x16x32_bf16 a[16:19], v[68:71], v[160:163], a[16:19]
    buffer_load_dword v117, v19, s[16:19], s35 offen
    v_mfma_f32_16x16x32_bf16 a[20:23], v[68:71], v[164:167], a[20:23]
    buffer_load_dword v118, v20, s[16:19], s35 offen
    v_mfma_f32_16x16x32_bf16 a[24:27], v[68:71], v[168:171], a[24:27]
    buffer_load_dword v119, v21, s[16:19], s35 offen
    buffer_load_dword v120, v14, s[16:19], s35 offen offset:1024
    v_mfma_f32_16x16x32_bf16 a[28:31], v[68:71], v[172:175], a[28:31]
    buffer_load_dword v121, v15, s[16:19], s35 offen offset:1024
    v_mfma_f32_16x16x32_bf16 a[32:35], v[72:75], v[160:163], a[32:35]
    buffer_load_dword v122, v16, s[16:19], s35 offen offset:1024
    v_mfma_f32_16x16x32_bf16 a[36:39], v[72:75], v[164:167], a[36:39]
    buffer_load_dword v123, v17, s[16:19], s35 offen offset:1024
    buffer_load_dword v124, v18, s[16:19], s35 offen offset:1024
    v_mfma_f32_16x16x32_bf16 a[40:43], v[72:75], v[168:171], a[40:43]
    buffer_load_dword v125, v19, s[16:19], s35 offen offset:1024
    v_mfma_f32_16x16x32_bf16 a[44:47], v[72:75], v[172:175], a[44:47]
    buffer_load_dword v126, v20, s[16:19], s35 offen offset:1024
    v_mfma_f32_16x16x32_bf16 a[48:51], v[76:79], v[160:163], a[48:51]
    buffer_load_dword v127, v21, s[16:19], s35 offen offset:1024
    ds_read_b128 v[32:35], v12 offset:0
    v_mfma_f32_16x16x32_bf16 a[52:55], v[76:79], v[164:167], a[52:55]
    ds_read_b128 v[36:39], v12 offset:2048
    v_mfma_f32_16x16x32_bf16 a[56:59], v[76:79], v[168:171], a[56:59]
    ds_read_b128 v[40:43], v12 offset:4096
    v_mfma_f32_16x16x32_bf16 a[60:63], v[76:79], v[172:175], a[60:63]
    ds_read_b128 v[44:47], v12 offset:6144
    v_mfma_f32_16x16x32_bf16 a[64:67], v[80:83], v[160:163], a[64:67]
    ds_read_b128 v[48:51], v12 offset:8192
    ds_read_b128 v[52:55], v12 offset:10240
    v_mfma_f32_16x16x32_bf16 a[68:71], v[80:83], v[164:167], a[68:71]
    ds_read_b128 v[56:59], v12 offset:12288
    v_mfma_f32_16x16x32_bf16 a[72:75], v[80:83], v[168:171], a[72:75]
    ds_read_b128 v[60:63], v12 offset:14336
    v_mfma_f32_16x16x32_bf16 a[76:79], v[80:83], v[172:175], a[76:79]
    s_waitcnt vmcnt(32)
    v_perm_b32 v144, v129, v128, s30
    v_mfma_f32_16x16x32_bf16 a[80:83], v[84:87], v[160:163], a[80:83]
    v_perm_b32 v148, v129, v128, s31
    v_mfma_f32_16x16x32_bf16 a[84:87], v[84:87], v[164:167], a[84:87]
    v_perm_b32 v145, v131, v130, s30
    v_mfma_f32_16x16x32_bf16 a[88:91], v[84:87], v[168:171], a[88:91]
    v_perm_b32 v149, v131, v130, s31
    v_perm_b32 v146, v133, v132, s30
    v_mfma_f32_16x16x32_bf16 a[92:95], v[84:87], v[172:175], a[92:95]
    v_perm_b32 v150, v133, v132, s31
    v_mfma_f32_16x16x32_bf16 a[96:99], v[88:91], v[160:163], a[96:99]
    v_perm_b32 v147, v135, v134, s30
    v_mfma_f32_16x16x32_bf16 a[100:103], v[88:91], v[164:167], a[100:103]
    v_perm_b32 v151, v135, v134, s31
    v_perm_b32 v152, v137, v136, s30
    v_mfma_f32_16x16x32_bf16 a[104:107], v[88:91], v[168:171], a[104:107]
    v_perm_b32 v156, v137, v136, s31
    v_mfma_f32_16x16x32_bf16 a[108:111], v[88:91], v[172:175], a[108:111]
    v_perm_b32 v153, v139, v138, s30
    v_mfma_f32_16x16x32_bf16 a[112:115], v[92:95], v[160:163], a[112:115]
    v_perm_b32 v157, v139, v138, s31
    v_perm_b32 v154, v141, v140, s30
    v_mfma_f32_16x16x32_bf16 a[116:119], v[92:95], v[164:167], a[116:119]
    v_perm_b32 v158, v141, v140, s31
    v_mfma_f32_16x16x32_bf16 a[120:123], v[92:95], v[168:171], a[120:123]
    v_perm_b32 v155, v143, v142, s30
    v_mfma_f32_16x16x32_bf16 a[124:127], v[92:95], v[172:175], a[124:127]
    v_perm_b32 v159, v143, v142, s31
    s_waitcnt lgkmcnt(0)
    v_mfma_f32_16x16x32_bf16 a[0:3], v[32:35], v[144:147], a[0:3]
    s_add_u32 s36, s32, 196608
    buffer_load_dword v128, v14, s[16:19], s36 offen
    v_mfma_f32_16x16x32_bf16 a[4:7], v[32:35], v[148:151], a[4:7]
    buffer_load_dword v129, v15, s[16:19], s36 offen
    v_mfma_f32_16x16x32_bf16 a[8:11], v[32:35], v[152:155], a[8:11]
    buffer_load_dword v130, v16, s[16:19], s36 offen
    v_mfma_f32_16x16x32_bf16 a[12:15], v[32:35], v[156:159], a[12:15]
    buffer_load_dword v131, v17, s[16:19], s36 offen
    buffer_load_dword v132, v18, s[16:19], s36 offen
    v_mfma_f32_16x16x32_bf16 a[16:19], v[36:39], v[144:147], a[16:19]
    buffer_load_dword v133, v19, s[16:19], s36 offen
    v_mfma_f32_16x16x32_bf16 a[20:23], v[36:39], v[148:151], a[20:23]
    buffer_load_dword v134, v20, s[16:19], s36 offen
    v_mfma_f32_16x16x32_bf16 a[24:27], v[36:39], v[152:155], a[24:27]
    buffer_load_dword v135, v21, s[16:19], s36 offen
    buffer_load_dword v136, v14, s[16:19], s36 offen offset:1024
    v_mfma_f32_16x16x32_bf16 a[28:31], v[36:39], v[156:159], a[28:31]
    buffer_load_dword v137, v15, s[16:19], s36 offen offset:1024
    v_mfma_f32_16x16x32_bf16 a[32:35], v[40:43], v[144:147], a[32:35]
    buffer_load_dword v138, v16, s[16:19], s36 offen offset:1024
    v_mfma_f32_16x16x32_bf16 a[36:39], v[40:43], v[148:151], a[36:39]
    buffer_load_dword v139, v17, s[16:19], s36 offen offset:1024
    buffer_load_dword v140, v18, s[16:19], s36 offen offset:1024
    v_mfma_f32_16x16x32_bf16 a[40:43], v[40:43], v[152:155], a[40:43]
    buffer_load_dword v141, v19, s[16:19], s36 offen offset:1024
    v_mfma_f32_16x16x32_bf16 a[44:47], v[40:43], v[156:159], a[44:47]
    buffer_load_dword v142, v20, s[16:19], s36 offen offset:1024
    v_mfma_f32_16x16x32_bf16 a[48:51], v[44:47], v[144:147], a[48:51]
    buffer_load_dword v143, v21, s[16:19], s36 offen offset:1024
    ds_read_b128 v[64:67], v13 offset:0
    v_mfma_f32_16x16x32_bf16 a[52:55], v[44:47], v[148:151], a[52:55]
    ds_read_b128 v[68:71], v13 offset:2048
    v_mfma_f32_16x16x32_bf16 a[56:59], v[44:47], v[152:155], a[56:59]
    ds_read_b128 v[72:75], v13 offset:4096
    v_mfma_f32_16x16x32_bf16 a[60:63], v[44:47], v[156:159], a[60:63]
    ds_read_b128 v[76:79], v13 offset:6144
    v_mfma_f32_16x16x32_bf16 a[64:67], v[48:51], v[144:147], a[64:67]
    ds_read_b128 v[80:83], v13 offset:8192
    ds_read_b128 v[84:87], v13 offset:10240
    v_mfma_f32_16x16x32_bf16 a[68:71], v[48:51], v[148:151], a[68:71]
    ds_read_b128 v[88:91], v13 offset:12288
    v_mfma_f32_16x16x32_bf16 a[72:75], v[48:51], v[152:155], a[72:75]
    ds_read_b128 v[92:95], v13 offset:14336
    v_mfma_f32_16x16x32_bf16 a[76:79], v[48:51], v[156:159], a[76:79]
    s_waitcnt vmcnt(32)
    v_perm_b32 v160, v97, v96, s30
    v_mfma_f32_16x16x32_bf16 a[80:83], v[52:55], v[144:147], a[80:83]
    v_perm_b32 v164, v97, v96, s31
    v_mfma_f32_16x16x32_bf16 a[84:87], v[52:55], v[148:151], a[84:87]
    v_perm_b32 v161, v99, v98, s30
    v_mfma_f32_16x16x32_bf16 a[88:91], v[52:55], v[152:155], a[88:91]
    v_perm_b32 v165, v99, v98, s31
    v_perm_b32 v162, v101, v100, s30
    v_mfma_f32_16x16x32_bf16 a[92:95], v[52:55], v[156:159], a[92:95]
    v_perm_b32 v166, v101, v100, s31
    v_mfma_f32_16x16x32_bf16 a[96:99], v[56:59], v[144:147], a[96:99]
    v_perm_b32 v163, v103, v102, s30
    v_mfma_f32_16x16x32_bf16 a[100:103], v[56:59], v[148:151], a[100:103]
    v_perm_b32 v167, v103, v102, s31
    v_perm_b32 v168, v105, v104, s30
    v_mfma_f32_16x16x32_bf16 a[104:107], v[56:59], v[152:155], a[104:107]
    v_perm_b32 v172, v105, v104, s31
    v_mfma_f32_16x16x32_bf16 a[108:111], v[56:59], v[156:159], a[108:111]
    v_perm_b32 v169, v107, v106, s30
    v_mfma_f32_16x16x32_bf16 a[112:115], v[60:63], v[144:147], a[112:115]
    v_perm_b32 v173, v107, v106, s31
    v_perm_b32 v170, v109, v108, s30
    v_mfma_f32_16x16x32_bf16 a[116:119], v[60:63], v[148:151], a[116:119]
    v_perm_b32 v174, v109, v108, s31
    v_mfma_f32_16x16x32_bf16 a[120:123], v[60:63], v[152:155], a[120:123]
    v_perm_b32 v171, v111, v110, s30
    v_mfma_f32_16x16x32_bf16 a[124:127], v[60:63], v[156:159], a[124:127]
    v_perm_b32 v175, v111, v110, s31
    s_waitcnt lgkmcnt(0)
    v_mfma_f32_16x16x32_bf16 a[0:3], v[64:67], v[160:163], a[0:3]
    s_add_u32 s33, s32, 1179648
    buffer_load_dword v96, v14, s[16:19], s33 offen
    v_mfma_f32_16x16x32_bf16 a[4:7], v[64:67], v[164:167], a[4:7]
    buffer_load_dword v97, v15, s[16:19], s33 offen
    v_mfma_f32_16x16x32_bf16 a[8:11], v[64:67], v[168:171], a[8:11]
    buffer_load_dword v98, v16, s[16:19], s33 offen
    buffer_load_dword v99, v17, s[16:19], s33 offen
    v_mfma_f32_16x16x32_bf16 a[12:15], v[64:67], v[172:175], a[12:15]
    buffer_load_dword v100, v18, s[16:19], s33 offen
    v_mfma_f32_16x16x32_bf16 a[16:19], v[68:71], v[160:163], a[16:19]
    buffer_load_dword v101, v19, s[16:19], s33 offen
    v_mfma_f32_16x16x32_bf16 a[20:23], v[68:71], v[164:167], a[20:23]
    buffer_load_dword v102, v20, s[16:19], s33 offen
    buffer_load_dword v103, v21, s[16:19], s33 offen
    v_mfma_f32_16x16x32_bf16 a[24:27], v[68:71], v[168:171], a[24:27]
    buffer_load_dword v104, v14, s[16:19], s33 offen offset:1024
    v_mfma_f32_16x16x32_bf16 a[28:31], v[68:71], v[172:175], a[28:31]
    buffer_load_dword v105, v15, s[16:19], s33 offen offset:1024
    v_mfma_f32_16x16x32_bf16 a[32:35], v[72:75], v[160:163], a[32:35]
    buffer_load_dword v106, v16, s[16:19], s33 offen offset:1024
    buffer_load_dword v107, v17, s[16:19], s33 offen offset:1024
    v_mfma_f32_16x16x32_bf16 a[36:39], v[72:75], v[164:167], a[36:39]
    buffer_load_dword v108, v18, s[16:19], s33 offen offset:1024
    v_mfma_f32_16x16x32_bf16 a[40:43], v[72:75], v[168:171], a[40:43]
    buffer_load_dword v109, v19, s[16:19], s33 offen offset:1024
    v_mfma_f32_16x16x32_bf16 a[44:47], v[72:75], v[172:175], a[44:47]
    buffer_load_dword v110, v20, s[16:19], s33 offen offset:1024
    buffer_load_dword v111, v21, s[16:19], s33 offen offset:1024
    v_mfma_f32_16x16x32_bf16 a[48:51], v[76:79], v[160:163], a[48:51]
    v_mfma_f32_16x16x32_bf16 a[52:55], v[76:79], v[164:167], a[52:55]
    ds_read_b128 v[32:35], v4 offset:17408
    v_mfma_f32_16x16x32_bf16 a[56:59], v[76:79], v[168:171], a[56:59]
    ds_read_b128 v[36:39], v4 offset:19456
    ds_read_b128 v[40:43], v4 offset:21504
    v_mfma_f32_16x16x32_bf16 a[60:63], v[76:79], v[172:175], a[60:63]
    ds_read_b128 v[44:47], v4 offset:23552
    v_mfma_f32_16x16x32_bf16 a[64:67], v[80:83], v[160:163], a[64:67]
    ds_read_b128 v[48:51], v4 offset:25600
    v_mfma_f32_16x16x32_bf16 a[68:71], v[80:83], v[164:167], a[68:71]
    ds_read_b128 v[52:55], v4 offset:27648
    ds_read_b128 v[56:59], v4 offset:29696
    v_mfma_f32_16x16x32_bf16 a[72:75], v[80:83], v[168:171], a[72:75]
    ds_read_b128 v[60:63], v4 offset:31744
    v_mfma_f32_16x16x32_bf16 a[76:79], v[80:83], v[172:175], a[76:79]
    s_waitcnt vmcnt(32)
    v_mfma_f32_16x16x32_bf16 a[80:83], v[84:87], v[160:163], a[80:83]
    v_perm_b32 v144, v113, v112, s30
    v_perm_b32 v148, v113, v112, s31
    v_mfma_f32_16x16x32_bf16 a[84:87], v[84:87], v[164:167], a[84:87]
    v_perm_b32 v145, v115, v114, s30
    v_mfma_f32_16x16x32_bf16 a[88:91], v[84:87], v[168:171], a[88:91]
    v_perm_b32 v149, v115, v114, s31
    v_mfma_f32_16x16x32_bf16 a[92:95], v[84:87], v[172:175], a[92:95]
    v_perm_b32 v146, v117, v116, s30
    v_perm_b32 v150, v117, v116, s31
    v_mfma_f32_16x16x32_bf16 a[96:99], v[88:91], v[160:163], a[96:99]
    v_perm_b32 v147, v119, v118, s30
    v_mfma_f32_16x16x32_bf16 a[100:103], v[88:91], v[164:167], a[100:103]
    v_perm_b32 v151, v119, v118, s31
    v_mfma_f32_16x16x32_bf16 a[104:107], v[88:91], v[168:171], a[104:107]
    v_perm_b32 v152, v121, v120, s30
    v_perm_b32 v156, v121, v120, s31
    v_mfma_f32_16x16x32_bf16 a[108:111], v[88:91], v[172:175], a[108:111]
    v_perm_b32 v153, v123, v122, s30
    v_mfma_f32_16x16x32_bf16 a[112:115], v[92:95], v[160:163], a[112:115]
    v_perm_b32 v157, v123, v122, s31
    v_mfma_f32_16x16x32_bf16 a[116:119], v[92:95], v[164:167], a[116:119]
    v_perm_b32 v154, v125, v124, s30
    v_perm_b32 v158, v125, v124, s31
    v_mfma_f32_16x16x32_bf16 a[120:123], v[92:95], v[168:171], a[120:123]
    v_perm_b32 v155, v127, v126, s30
    v_mfma_f32_16x16x32_bf16 a[124:127], v[92:95], v[172:175], a[124:127]
    v_perm_b32 v159, v127, v126, s31
    s_waitcnt lgkmcnt(0)
    v_mfma_f32_16x16x32_bf16 a[0:3], v[32:35], v[144:147], a[0:3]
    s_add_u32 s34, s32, 1245184
    buffer_load_dword v112, v14, s[16:19], s34 offen
    v_mfma_f32_16x16x32_bf16 a[4:7], v[32:35], v[148:151], a[4:7]
    buffer_load_dword v113, v15, s[16:19], s34 offen
    v_mfma_f32_16x16x32_bf16 a[8:11], v[32:35], v[152:155], a[8:11]
    buffer_load_dword v114, v16, s[16:19], s34 offen
    v_mfma_f32_16x16x32_bf16 a[12:15], v[32:35], v[156:159], a[12:15]
    buffer_load_dword v115, v17, s[16:19], s34 offen
    buffer_load_dword v116, v18, s[16:19], s34 offen
    v_mfma_f32_16x16x32_bf16 a[16:19], v[36:39], v[144:147], a[16:19]
    buffer_load_dword v117, v19, s[16:19], s34 offen
    v_mfma_f32_16x16x32_bf16 a[20:23], v[36:39], v[148:151], a[20:23]
    buffer_load_dword v118, v20, s[16:19], s34 offen
    v_mfma_f32_16x16x32_bf16 a[24:27], v[36:39], v[152:155], a[24:27]
    buffer_load_dword v119, v21, s[16:19], s34 offen
    buffer_load_dword v120, v14, s[16:19], s34 offen offset:1024
    v_mfma_f32_16x16x32_bf16 a[28:31], v[36:39], v[156:159], a[28:31]
    buffer_load_dword v121, v15, s[16:19], s34 offen offset:1024
    v_mfma_f32_16x16x32_bf16 a[32:35], v[40:43], v[144:147], a[32:35]
    buffer_load_dword v122, v16, s[16:19], s34 offen offset:1024
    v_mfma_f32_16x16x32_bf16 a[36:39], v[40:43], v[148:151], a[36:39]
    buffer_load_dword v123, v17, s[16:19], s34 offen offset:1024
    buffer_load_dword v124, v18, s[16:19], s34 offen offset:1024
    v_mfma_f32_16x16x32_bf16 a[40:43], v[40:43], v[152:155], a[40:43]
    buffer_load_dword v125, v19, s[16:19], s34 offen offset:1024
    v_mfma_f32_16x16x32_bf16 a[44:47], v[40:43], v[156:159], a[44:47]
    buffer_load_dword v126, v20, s[16:19], s34 offen offset:1024
    v_mfma_f32_16x16x32_bf16 a[48:51], v[44:47], v[144:147], a[48:51]
    buffer_load_dword v127, v21, s[16:19], s34 offen offset:1024
    ds_read_b128 v[64:67], v5 offset:17408
    v_mfma_f32_16x16x32_bf16 a[52:55], v[44:47], v[148:151], a[52:55]
    ds_read_b128 v[68:71], v5 offset:19456
    v_mfma_f32_16x16x32_bf16 a[56:59], v[44:47], v[152:155], a[56:59]
    ds_read_b128 v[72:75], v5 offset:21504
    v_mfma_f32_16x16x32_bf16 a[60:63], v[44:47], v[156:159], a[60:63]
    ds_read_b128 v[76:79], v5 offset:23552
    v_mfma_f32_16x16x32_bf16 a[64:67], v[48:51], v[144:147], a[64:67]
    ds_read_b128 v[80:83], v5 offset:25600
    ds_read_b128 v[84:87], v5 offset:27648
    v_mfma_f32_16x16x32_bf16 a[68:71], v[48:51], v[148:151], a[68:71]
    ds_read_b128 v[88:91], v5 offset:29696
    v_mfma_f32_16x16x32_bf16 a[72:75], v[48:51], v[152:155], a[72:75]
    ds_read_b128 v[92:95], v5 offset:31744
    v_mfma_f32_16x16x32_bf16 a[76:79], v[48:51], v[156:159], a[76:79]
    s_waitcnt vmcnt(32)
    v_perm_b32 v160, v129, v128, s30
    v_mfma_f32_16x16x32_bf16 a[80:83], v[52:55], v[144:147], a[80:83]
    v_perm_b32 v164, v129, v128, s31
    v_mfma_f32_16x16x32_bf16 a[84:87], v[52:55], v[148:151], a[84:87]
    v_perm_b32 v161, v131, v130, s30
    v_mfma_f32_16x16x32_bf16 a[88:91], v[52:55], v[152:155], a[88:91]
    v_perm_b32 v165, v131, v130, s31
    v_perm_b32 v162, v133, v132, s30
    v_mfma_f32_16x16x32_bf16 a[92:95], v[52:55], v[156:159], a[92:95]
    v_perm_b32 v166, v133, v132, s31
    v_mfma_f32_16x16x32_bf16 a[96:99], v[56:59], v[144:147], a[96:99]
    v_perm_b32 v163, v135, v134, s30
    v_mfma_f32_16x16x32_bf16 a[100:103], v[56:59], v[148:151], a[100:103]
    v_perm_b32 v167, v135, v134, s31
    v_perm_b32 v168, v137, v136, s30
    v_mfma_f32_16x16x32_bf16 a[104:107], v[56:59], v[152:155], a[104:107]
    v_perm_b32 v172, v137, v136, s31
    v_mfma_f32_16x16x32_bf16 a[108:111], v[56:59], v[156:159], a[108:111]
    v_perm_b32 v169, v139, v138, s30
    v_mfma_f32_16x16x32_bf16 a[112:115], v[60:63], v[144:147], a[112:115]
    v_perm_b32 v173, v139, v138, s31
    v_perm_b32 v170, v141, v140, s30
    v_mfma_f32_16x16x32_bf16 a[116:119], v[60:63], v[148:151], a[116:119]
    v_perm_b32 v174, v141, v140, s31
    v_mfma_f32_16x16x32_bf16 a[120:123], v[60:63], v[152:155], a[120:123]
    v_perm_b32 v171, v143, v142, s30
    v_mfma_f32_16x16x32_bf16 a[124:127], v[60:63], v[156:159], a[124:127]
    v_perm_b32 v175, v143, v142, s31
    s_waitcnt lgkmcnt(0)
    v_mfma_f32_16x16x32_bf16 a[0:3], v[64:67], v[160:163], a[0:3]
    s_add_u32 s35, s32, 2228224
    buffer_load_dword v128, v14, s[16:19], s35 offen
    v_mfma_f32_16x16x32_bf16 a[4:7], v[64:67], v[164:167], a[4:7]
    buffer_load_dword v129, v15, s[16:19], s35 offen
    v_mfma_f32_16x16x32_bf16 a[8:11], v[64:67], v[168:171], a[8:11]
    buffer_load_dword v130, v16, s[16:19], s35 offen
    v_mfma_f32_16x16x32_bf16 a[12:15], v[64:67], v[172:175], a[12:15]
    buffer_load_dword v131, v17, s[16:19], s35 offen
    buffer_load_dword v132, v18, s[16:19], s35 offen
    v_mfma_f32_16x16x32_bf16 a[16:19], v[68:71], v[160:163], a[16:19]
    buffer_load_dword v133, v19, s[16:19], s35 offen
    v_mfma_f32_16x16x32_bf16 a[20:23], v[68:71], v[164:167], a[20:23]
    buffer_load_dword v134, v20, s[16:19], s35 offen
    v_mfma_f32_16x16x32_bf16 a[24:27], v[68:71], v[168:171], a[24:27]
    buffer_load_dword v135, v21, s[16:19], s35 offen
    buffer_load_dword v136, v14, s[16:19], s35 offen offset:1024
    v_mfma_f32_16x16x32_bf16 a[28:31], v[68:71], v[172:175], a[28:31]
    buffer_load_dword v137, v15, s[16:19], s35 offen offset:1024
    v_mfma_f32_16x16x32_bf16 a[32:35], v[72:75], v[160:163], a[32:35]
    buffer_load_dword v138, v16, s[16:19], s35 offen offset:1024
    v_mfma_f32_16x16x32_bf16 a[36:39], v[72:75], v[164:167], a[36:39]
    buffer_load_dword v139, v17, s[16:19], s35 offen offset:1024
    buffer_load_dword v140, v18, s[16:19], s35 offen offset:1024
    v_mfma_f32_16x16x32_bf16 a[40:43], v[72:75], v[168:171], a[40:43]
    buffer_load_dword v141, v19, s[16:19], s35 offen offset:1024
    v_mfma_f32_16x16x32_bf16 a[44:47], v[72:75], v[172:175], a[44:47]
    buffer_load_dword v142, v20, s[16:19], s35 offen offset:1024
    v_mfma_f32_16x16x32_bf16 a[48:51], v[76:79], v[160:163], a[48:51]
    buffer_load_dword v143, v21, s[16:19], s35 offen offset:1024
    ds_read_b128 v[32:35], v6 offset:17408
    v_mfma_f32_16x16x32_bf16 a[52:55], v[76:79], v[164:167], a[52:55]
    ds_read_b128 v[36:39], v6 offset:19456
    v_mfma_f32_16x16x32_bf16 a[56:59], v[76:79], v[168:171], a[56:59]
    ds_read_b128 v[40:43], v6 offset:21504
    v_mfma_f32_16x16x32_bf16 a[60:63], v[76:79], v[172:175], a[60:63]
    ds_read_b128 v[44:47], v6 offset:23552
    v_mfma_f32_16x16x32_bf16 a[64:67], v[80:83], v[160:163], a[64:67]
    ds_read_b128 v[48:51], v6 offset:25600
    ds_read_b128 v[52:55], v6 offset:27648
    v_mfma_f32_16x16x32_bf16 a[68:71], v[80:83], v[164:167], a[68:71]
    ds_read_b128 v[56:59], v6 offset:29696
    v_mfma_f32_16x16x32_bf16 a[72:75], v[80:83], v[168:171], a[72:75]
    ds_read_b128 v[60:63], v6 offset:31744
    v_mfma_f32_16x16x32_bf16 a[76:79], v[80:83], v[172:175], a[76:79]
    s_waitcnt vmcnt(32)
    v_perm_b32 v144, v97, v96, s30
    v_mfma_f32_16x16x32_bf16 a[80:83], v[84:87], v[160:163], a[80:83]
    v_perm_b32 v148, v97, v96, s31
    v_mfma_f32_16x16x32_bf16 a[84:87], v[84:87], v[164:167], a[84:87]
    v_perm_b32 v145, v99, v98, s30
    v_mfma_f32_16x16x32_bf16 a[88:91], v[84:87], v[168:171], a[88:91]
    v_perm_b32 v149, v99, v98, s31
    v_perm_b32 v146, v101, v100, s30
    v_mfma_f32_16x16x32_bf16 a[92:95], v[84:87], v[172:175], a[92:95]
    v_perm_b32 v150, v101, v100, s31
    v_mfma_f32_16x16x32_bf16 a[96:99], v[88:91], v[160:163], a[96:99]
    v_perm_b32 v147, v103, v102, s30
    v_mfma_f32_16x16x32_bf16 a[100:103], v[88:91], v[164:167], a[100:103]
    v_perm_b32 v151, v103, v102, s31
    v_perm_b32 v152, v105, v104, s30
    v_mfma_f32_16x16x32_bf16 a[104:107], v[88:91], v[168:171], a[104:107]
    v_perm_b32 v156, v105, v104, s31
    v_mfma_f32_16x16x32_bf16 a[108:111], v[88:91], v[172:175], a[108:111]
    v_perm_b32 v153, v107, v106, s30
    v_mfma_f32_16x16x32_bf16 a[112:115], v[92:95], v[160:163], a[112:115]
    v_perm_b32 v157, v107, v106, s31
    v_perm_b32 v154, v109, v108, s30
    v_mfma_f32_16x16x32_bf16 a[116:119], v[92:95], v[164:167], a[116:119]
    v_perm_b32 v158, v109, v108, s31
    v_mfma_f32_16x16x32_bf16 a[120:123], v[92:95], v[168:171], a[120:123]
    v_perm_b32 v155, v111, v110, s30
    v_mfma_f32_16x16x32_bf16 a[124:127], v[92:95], v[172:175], a[124:127]
    v_perm_b32 v159, v111, v110, s31
    s_waitcnt lgkmcnt(0)
    v_mfma_f32_16x16x32_bf16 a[0:3], v[32:35], v[144:147], a[0:3]
    s_add_u32 s36, s32, 2293760
    buffer_load_dword v96, v14, s[16:19], s36 offen
    v_mfma_f32_16x16x32_bf16 a[4:7], v[32:35], v[148:151], a[4:7]
    buffer_load_dword v97, v15, s[16:19], s36 offen
    v_mfma_f32_16x16x32_bf16 a[8:11], v[32:35], v[152:155], a[8:11]
    buffer_load_dword v98, v16, s[16:19], s36 offen
    v_mfma_f32_16x16x32_bf16 a[12:15], v[32:35], v[156:159], a[12:15]
    buffer_load_dword v99, v17, s[16:19], s36 offen
    buffer_load_dword v100, v18, s[16:19], s36 offen
    v_mfma_f32_16x16x32_bf16 a[16:19], v[36:39], v[144:147], a[16:19]
    buffer_load_dword v101, v19, s[16:19], s36 offen
    v_mfma_f32_16x16x32_bf16 a[20:23], v[36:39], v[148:151], a[20:23]
    buffer_load_dword v102, v20, s[16:19], s36 offen
    v_mfma_f32_16x16x32_bf16 a[24:27], v[36:39], v[152:155], a[24:27]
    buffer_load_dword v103, v21, s[16:19], s36 offen
    buffer_load_dword v104, v14, s[16:19], s36 offen offset:1024
    v_mfma_f32_16x16x32_bf16 a[28:31], v[36:39], v[156:159], a[28:31]
    buffer_load_dword v105, v15, s[16:19], s36 offen offset:1024
    v_mfma_f32_16x16x32_bf16 a[32:35], v[40:43], v[144:147], a[32:35]
    buffer_load_dword v106, v16, s[16:19], s36 offen offset:1024
    v_mfma_f32_16x16x32_bf16 a[36:39], v[40:43], v[148:151], a[36:39]
    buffer_load_dword v107, v17, s[16:19], s36 offen offset:1024
    buffer_load_dword v108, v18, s[16:19], s36 offen offset:1024
    v_mfma_f32_16x16x32_bf16 a[40:43], v[40:43], v[152:155], a[40:43]
    buffer_load_dword v109, v19, s[16:19], s36 offen offset:1024
    v_mfma_f32_16x16x32_bf16 a[44:47], v[40:43], v[156:159], a[44:47]
    buffer_load_dword v110, v20, s[16:19], s36 offen offset:1024
    v_mfma_f32_16x16x32_bf16 a[48:51], v[44:47], v[144:147], a[48:51]
    buffer_load_dword v111, v21, s[16:19], s36 offen offset:1024
    ds_read_b128 v[64:67], v7 offset:17408
    v_mfma_f32_16x16x32_bf16 a[52:55], v[44:47], v[148:151], a[52:55]
    ds_read_b128 v[68:71], v7 offset:19456
    v_mfma_f32_16x16x32_bf16 a[56:59], v[44:47], v[152:155], a[56:59]
    ds_read_b128 v[72:75], v7 offset:21504
    v_mfma_f32_16x16x32_bf16 a[60:63], v[44:47], v[156:159], a[60:63]
    ds_read_b128 v[76:79], v7 offset:23552
    v_mfma_f32_16x16x32_bf16 a[64:67], v[48:51], v[144:147], a[64:67]
    ds_read_b128 v[80:83], v7 offset:25600
    ds_read_b128 v[84:87], v7 offset:27648
    v_mfma_f32_16x16x32_bf16 a[68:71], v[48:51], v[148:151], a[68:71]
    ds_read_b128 v[88:91], v7 offset:29696
    v_mfma_f32_16x16x32_bf16 a[72:75], v[48:51], v[152:155], a[72:75]
    ds_read_b128 v[92:95], v7 offset:31744
    v_mfma_f32_16x16x32_bf16 a[76:79], v[48:51], v[156:159], a[76:79]
    s_waitcnt vmcnt(32)
    v_perm_b32 v160, v113, v112, s30
    v_mfma_f32_16x16x32_bf16 a[80:83], v[52:55], v[144:147], a[80:83]
    v_perm_b32 v164, v113, v112, s31
    v_mfma_f32_16x16x32_bf16 a[84:87], v[52:55], v[148:151], a[84:87]
    v_perm_b32 v161, v115, v114, s30
    v_mfma_f32_16x16x32_bf16 a[88:91], v[52:55], v[152:155], a[88:91]
    v_perm_b32 v165, v115, v114, s31
    v_perm_b32 v162, v117, v116, s30
    v_mfma_f32_16x16x32_bf16 a[92:95], v[52:55], v[156:159], a[92:95]
    v_perm_b32 v166, v117, v116, s31
    v_mfma_f32_16x16x32_bf16 a[96:99], v[56:59], v[144:147], a[96:99]
    v_perm_b32 v163, v119, v118, s30
    v_mfma_f32_16x16x32_bf16 a[100:103], v[56:59], v[148:151], a[100:103]
    v_perm_b32 v167, v119, v118, s31
    v_perm_b32 v168, v121, v120, s30
    v_mfma_f32_16x16x32_bf16 a[104:107], v[56:59], v[152:155], a[104:107]
    v_perm_b32 v172, v121, v120, s31
    v_mfma_f32_16x16x32_bf16 a[108:111], v[56:59], v[156:159], a[108:111]
    v_perm_b32 v169, v123, v122, s30
    v_mfma_f32_16x16x32_bf16 a[112:115], v[60:63], v[144:147], a[112:115]
    v_perm_b32 v173, v123, v122, s31
    v_perm_b32 v170, v125, v124, s30
    v_mfma_f32_16x16x32_bf16 a[116:119], v[60:63], v[148:151], a[116:119]
    v_perm_b32 v174, v125, v124, s31
    v_mfma_f32_16x16x32_bf16 a[120:123], v[60:63], v[152:155], a[120:123]
    v_perm_b32 v171, v127, v126, s30
    v_mfma_f32_16x16x32_bf16 a[124:127], v[60:63], v[156:159], a[124:127]
    v_perm_b32 v175, v127, v126, s31
    s_waitcnt lgkmcnt(0)
    v_mfma_f32_16x16x32_bf16 a[0:3], v[64:67], v[160:163], a[0:3]
    s_add_u32 s33, s32, 3276800
    buffer_load_dword v112, v14, s[16:19], s33 offen
    v_mfma_f32_16x16x32_bf16 a[4:7], v[64:67], v[164:167], a[4:7]
    buffer_load_dword v113, v15, s[16:19], s33 offen
    v_mfma_f32_16x16x32_bf16 a[8:11], v[64:67], v[168:171], a[8:11]
    buffer_load_dword v114, v16, s[16:19], s33 offen
    v_mfma_f32_16x16x32_bf16 a[12:15], v[64:67], v[172:175], a[12:15]
    buffer_load_dword v115, v17, s[16:19], s33 offen
    buffer_load_dword v116, v18, s[16:19], s33 offen
    v_mfma_f32_16x16x32_bf16 a[16:19], v[68:71], v[160:163], a[16:19]
    buffer_load_dword v117, v19, s[16:19], s33 offen
    v_mfma_f32_16x16x32_bf16 a[20:23], v[68:71], v[164:167], a[20:23]
    buffer_load_dword v118, v20, s[16:19], s33 offen
    v_mfma_f32_16x16x32_bf16 a[24:27], v[68:71], v[168:171], a[24:27]
    buffer_load_dword v119, v21, s[16:19], s33 offen
    buffer_load_dword v120, v14, s[16:19], s33 offen offset:1024
    v_mfma_f32_16x16x32_bf16 a[28:31], v[68:71], v[172:175], a[28:31]
    buffer_load_dword v121, v15, s[16:19], s33 offen offset:1024
    v_mfma_f32_16x16x32_bf16 a[32:35], v[72:75], v[160:163], a[32:35]
    buffer_load_dword v122, v16, s[16:19], s33 offen offset:1024
    v_mfma_f32_16x16x32_bf16 a[36:39], v[72:75], v[164:167], a[36:39]
    buffer_load_dword v123, v17, s[16:19], s33 offen offset:1024
    buffer_load_dword v124, v18, s[16:19], s33 offen offset:1024
    v_mfma_f32_16x16x32_bf16 a[40:43], v[72:75], v[168:171], a[40:43]
    buffer_load_dword v125, v19, s[16:19], s33 offen offset:1024
    v_mfma_f32_16x16x32_bf16 a[44:47], v[72:75], v[172:175], a[44:47]
    buffer_load_dword v126, v20, s[16:19], s33 offen offset:1024
    v_mfma_f32_16x16x32_bf16 a[48:51], v[76:79], v[160:163], a[48:51]
    buffer_load_dword v127, v21, s[16:19], s33 offen offset:1024
    ds_read_b128 v[32:35], v8 offset:17408
    v_mfma_f32_16x16x32_bf16 a[52:55], v[76:79], v[164:167], a[52:55]
    ds_read_b128 v[36:39], v8 offset:19456
    v_mfma_f32_16x16x32_bf16 a[56:59], v[76:79], v[168:171], a[56:59]
    ds_read_b128 v[40:43], v8 offset:21504
    v_mfma_f32_16x16x32_bf16 a[60:63], v[76:79], v[172:175], a[60:63]
    ds_read_b128 v[44:47], v8 offset:23552
    v_mfma_f32_16x16x32_bf16 a[64:67], v[80:83], v[160:163], a[64:67]
    ds_read_b128 v[48:51], v8 offset:25600
    ds_read_b128 v[52:55], v8 offset:27648
    v_mfma_f32_16x16x32_bf16 a[68:71], v[80:83], v[164:167], a[68:71]
    ds_read_b128 v[56:59], v8 offset:29696
    v_mfma_f32_16x16x32_bf16 a[72:75], v[80:83], v[168:171], a[72:75]
    ds_read_b128 v[60:63], v8 offset:31744
    v_mfma_f32_16x16x32_bf16 a[76:79], v[80:83], v[172:175], a[76:79]
    s_waitcnt vmcnt(32)
    v_perm_b32 v144, v129, v128, s30
    v_mfma_f32_16x16x32_bf16 a[80:83], v[84:87], v[160:163], a[80:83]
    v_perm_b32 v148, v129, v128, s31
    v_mfma_f32_16x16x32_bf16 a[84:87], v[84:87], v[164:167], a[84:87]
    v_perm_b32 v145, v131, v130, s30
    v_mfma_f32_16x16x32_bf16 a[88:91], v[84:87], v[168:171], a[88:91]
    v_perm_b32 v149, v131, v130, s31
    v_perm_b32 v146, v133, v132, s30
    v_mfma_f32_16x16x32_bf16 a[92:95], v[84:87], v[172:175], a[92:95]
    v_perm_b32 v150, v133, v132, s31
    v_mfma_f32_16x16x32_bf16 a[96:99], v[88:91], v[160:163], a[96:99]
    v_perm_b32 v147, v135, v134, s30
    v_mfma_f32_16x16x32_bf16 a[100:103], v[88:91], v[164:167], a[100:103]
    v_perm_b32 v151, v135, v134, s31
    v_perm_b32 v152, v137, v136, s30
    v_mfma_f32_16x16x32_bf16 a[104:107], v[88:91], v[168:171], a[104:107]
    v_perm_b32 v156, v137, v136, s31
    v_mfma_f32_16x16x32_bf16 a[108:111], v[88:91], v[172:175], a[108:111]
    v_perm_b32 v153, v139, v138, s30
    v_mfma_f32_16x16x32_bf16 a[112:115], v[92:95], v[160:163], a[112:115]
    v_perm_b32 v157, v139, v138, s31
    v_perm_b32 v154, v141, v140, s30
    v_mfma_f32_16x16x32_bf16 a[116:119], v[92:95], v[164:167], a[116:119]
    v_perm_b32 v158, v141, v140, s31
    v_mfma_f32_16x16x32_bf16 a[120:123], v[92:95], v[168:171], a[120:123]
    v_perm_b32 v155, v143, v142, s30
    v_mfma_f32_16x16x32_bf16 a[124:127], v[92:95], v[172:175], a[124:127]
    v_perm_b32 v159, v143, v142, s31
    s_waitcnt lgkmcnt(0)
    v_mfma_f32_16x16x32_bf16 a[0:3], v[32:35], v[144:147], a[0:3]
    s_add_u32 s34, s32, 3342336
    buffer_load_dword v128, v14, s[16:19], s34 offen
    v_mfma_f32_16x16x32_bf16 a[4:7], v[32:35], v[148:151], a[4:7]
    buffer_load_dword v129, v15, s[16:19], s34 offen
    v_mfma_f32_16x16x32_bf16 a[8:11], v[32:35], v[152:155], a[8:11]
    buffer_load_dword v130, v16, s[16:19], s34 offen
    v_mfma_f32_16x16x32_bf16 a[12:15], v[32:35], v[156:159], a[12:15]
    buffer_load_dword v131, v17, s[16:19], s34 offen
    buffer_load_dword v132, v18, s[16:19], s34 offen
    v_mfma_f32_16x16x32_bf16 a[16:19], v[36:39], v[144:147], a[16:19]
    buffer_load_dword v133, v19, s[16:19], s34 offen
    v_mfma_f32_16x16x32_bf16 a[20:23], v[36:39], v[148:151], a[20:23]
    buffer_load_dword v134, v20, s[16:19], s34 offen
    v_mfma_f32_16x16x32_bf16 a[24:27], v[36:39], v[152:155], a[24:27]
    buffer_load_dword v135, v21, s[16:19], s34 offen
    buffer_load_dword v136, v14, s[16:19], s34 offen offset:1024
    v_mfma_f32_16x16x32_bf16 a[28:31], v[36:39], v[156:159], a[28:31]
    buffer_load_dword v137, v15, s[16:19], s34 offen offset:1024
    v_mfma_f32_16x16x32_bf16 a[32:35], v[40:43], v[144:147], a[32:35]
    buffer_load_dword v138, v16, s[16:19], s34 offen offset:1024
    v_mfma_f32_16x16x32_bf16 a[36:39], v[40:43], v[148:151], a[36:39]
    buffer_load_dword v139, v17, s[16:19], s34 offen offset:1024
    buffer_load_dword v140, v18, s[16:19], s34 offen offset:1024
    v_mfma_f32_16x16x32_bf16 a[40:43], v[40:43], v[152:155], a[40:43]
    buffer_load_dword v141, v19, s[16:19], s34 offen offset:1024
    v_mfma_f32_16x16x32_bf16 a[44:47], v[40:43], v[156:159], a[44:47]
    buffer_load_dword v142, v20, s[16:19], s34 offen offset:1024
    v_mfma_f32_16x16x32_bf16 a[48:51], v[44:47], v[144:147], a[48:51]
    buffer_load_dword v143, v21, s[16:19], s34 offen offset:1024
    ds_read_b128 v[64:67], v9 offset:17408
    v_mfma_f32_16x16x32_bf16 a[52:55], v[44:47], v[148:151], a[52:55]
    ds_read_b128 v[68:71], v9 offset:19456
    v_mfma_f32_16x16x32_bf16 a[56:59], v[44:47], v[152:155], a[56:59]
    ds_read_b128 v[72:75], v9 offset:21504
    v_mfma_f32_16x16x32_bf16 a[60:63], v[44:47], v[156:159], a[60:63]
    ds_read_b128 v[76:79], v9 offset:23552
    v_mfma_f32_16x16x32_bf16 a[64:67], v[48:51], v[144:147], a[64:67]
    ds_read_b128 v[80:83], v9 offset:25600
    ds_read_b128 v[84:87], v9 offset:27648
    v_mfma_f32_16x16x32_bf16 a[68:71], v[48:51], v[148:151], a[68:71]
    ds_read_b128 v[88:91], v9 offset:29696
    v_mfma_f32_16x16x32_bf16 a[72:75], v[48:51], v[152:155], a[72:75]
    ds_read_b128 v[92:95], v9 offset:31744
    v_mfma_f32_16x16x32_bf16 a[76:79], v[48:51], v[156:159], a[76:79]
    s_waitcnt vmcnt(32)
    v_perm_b32 v160, v97, v96, s30
    v_mfma_f32_16x16x32_bf16 a[80:83], v[52:55], v[144:147], a[80:83]
    v_perm_b32 v164, v97, v96, s31
    v_mfma_f32_16x16x32_bf16 a[84:87], v[52:55], v[148:151], a[84:87]
    v_perm_b32 v161, v99, v98, s30
    v_mfma_f32_16x16x32_bf16 a[88:91], v[52:55], v[152:155], a[88:91]
    v_perm_b32 v165, v99, v98, s31
    v_perm_b32 v162, v101, v100, s30
    v_mfma_f32_16x16x32_bf16 a[92:95], v[52:55], v[156:159], a[92:95]
    v_perm_b32 v166, v101, v100, s31
    v_mfma_f32_16x16x32_bf16 a[96:99], v[56:59], v[144:147], a[96:99]
    v_perm_b32 v163, v103, v102, s30
    v_mfma_f32_16x16x32_bf16 a[100:103], v[56:59], v[148:151], a[100:103]
    v_perm_b32 v167, v103, v102, s31
    v_perm_b32 v168, v105, v104, s30
    v_mfma_f32_16x16x32_bf16 a[104:107], v[56:59], v[152:155], a[104:107]
    v_perm_b32 v172, v105, v104, s31
    v_mfma_f32_16x16x32_bf16 a[108:111], v[56:59], v[156:159], a[108:111]
    v_perm_b32 v169, v107, v106, s30
    v_mfma_f32_16x16x32_bf16 a[112:115], v[60:63], v[144:147], a[112:115]
    v_perm_b32 v173, v107, v106, s31
    v_perm_b32 v170, v109, v108, s30
    v_mfma_f32_16x16x32_bf16 a[116:119], v[60:63], v[148:151], a[116:119]
    v_perm_b32 v174, v109, v108, s31
    v_mfma_f32_16x16x32_bf16 a[120:123], v[60:63], v[152:155], a[120:123]
    v_perm_b32 v171, v111, v110, s30
    v_mfma_f32_16x16x32_bf16 a[124:127], v[60:63], v[156:159], a[124:127]
    v_perm_b32 v175, v111, v110, s31
    s_waitcnt lgkmcnt(0)
    v_mfma_f32_16x16x32_bf16 a[0:3], v[64:67], v[160:163], a[0:3]
    s_add_u32 s35, s32, 4325376
    buffer_load_dword v96, v14, s[16:19], s35 offen
    v_mfma_f32_16x16x32_bf16 a[4:7], v[64:67], v[164:167], a[4:7]
    buffer_load_dword v97, v15, s[16:19], s35 offen
    v_mfma_f32_16x16x32_bf16 a[8:11], v[64:67], v[168:171], a[8:11]
    buffer_load_dword v98, v16, s[16:19], s35 offen
    v_mfma_f32_16x16x32_bf16 a[12:15], v[64:67], v[172:175], a[12:15]
    buffer_load_dword v99, v17, s[16:19], s35 offen
    buffer_load_dword v100, v18, s[16:19], s35 offen
    v_mfma_f32_16x16x32_bf16 a[16:19], v[68:71], v[160:163], a[16:19]
    buffer_load_dword v101, v19, s[16:19], s35 offen
    v_mfma_f32_16x16x32_bf16 a[20:23], v[68:71], v[164:167], a[20:23]
    buffer_load_dword v102, v20, s[16:19], s35 offen
    v_mfma_f32_16x16x32_bf16 a[24:27], v[68:71], v[168:171], a[24:27]
    buffer_load_dword v103, v21, s[16:19], s35 offen
    buffer_load_dword v104, v14, s[16:19], s35 offen offset:1024
    v_mfma_f32_16x16x32_bf16 a[28:31], v[68:71], v[172:175], a[28:31]
    buffer_load_dword v105, v15, s[16:19], s35 offen offset:1024
    v_mfma_f32_16x16x32_bf16 a[32:35], v[72:75], v[160:163], a[32:35]
    buffer_load_dword v106, v16, s[16:19], s35 offen offset:1024
    v_mfma_f32_16x16x32_bf16 a[36:39], v[72:75], v[164:167], a[36:39]
    buffer_load_dword v107, v17, s[16:19], s35 offen offset:1024
    buffer_load_dword v108, v18, s[16:19], s35 offen offset:1024
    v_mfma_f32_16x16x32_bf16 a[40:43], v[72:75], v[168:171], a[40:43]
    buffer_load_dword v109, v19, s[16:19], s35 offen offset:1024
    v_mfma_f32_16x16x32_bf16 a[44:47], v[72:75], v[172:175], a[44:47]
    buffer_load_dword v110, v20, s[16:19], s35 offen offset:1024
    v_mfma_f32_16x16x32_bf16 a[48:51], v[76:79], v[160:163], a[48:51]
    buffer_load_dword v111, v21, s[16:19], s35 offen offset:1024
    ds_read_b128 v[32:35], v10 offset:17408
    v_mfma_f32_16x16x32_bf16 a[52:55], v[76:79], v[164:167], a[52:55]
    ds_read_b128 v[36:39], v10 offset:19456
    v_mfma_f32_16x16x32_bf16 a[56:59], v[76:79], v[168:171], a[56:59]
    ds_read_b128 v[40:43], v10 offset:21504
    v_mfma_f32_16x16x32_bf16 a[60:63], v[76:79], v[172:175], a[60:63]
    ds_read_b128 v[44:47], v10 offset:23552
    v_mfma_f32_16x16x32_bf16 a[64:67], v[80:83], v[160:163], a[64:67]
    ds_read_b128 v[48:51], v10 offset:25600
    ds_read_b128 v[52:55], v10 offset:27648
    v_mfma_f32_16x16x32_bf16 a[68:71], v[80:83], v[164:167], a[68:71]
    ds_read_b128 v[56:59], v10 offset:29696
    v_mfma_f32_16x16x32_bf16 a[72:75], v[80:83], v[168:171], a[72:75]
    ds_read_b128 v[60:63], v10 offset:31744
    v_mfma_f32_16x16x32_bf16 a[76:79], v[80:83], v[172:175], a[76:79]
    s_waitcnt vmcnt(32)
    v_perm_b32 v144, v113, v112, s30
    v_mfma_f32_16x16x32_bf16 a[80:83], v[84:87], v[160:163], a[80:83]
    v_perm_b32 v148, v113, v112, s31
    v_mfma_f32_16x16x32_bf16 a[84:87], v[84:87], v[164:167], a[84:87]
    v_perm_b32 v145, v115, v114, s30
    v_mfma_f32_16x16x32_bf16 a[88:91], v[84:87], v[168:171], a[88:91]
    v_perm_b32 v149, v115, v114, s31
    v_perm_b32 v146, v117, v116, s30
    v_mfma_f32_16x16x32_bf16 a[92:95], v[84:87], v[172:175], a[92:95]
    v_perm_b32 v150, v117, v116, s31
    v_mfma_f32_16x16x32_bf16 a[96:99], v[88:91], v[160:163], a[96:99]
    v_perm_b32 v147, v119, v118, s30
    v_mfma_f32_16x16x32_bf16 a[100:103], v[88:91], v[164:167], a[100:103]
    v_perm_b32 v151, v119, v118, s31
    v_perm_b32 v152, v121, v120, s30
    v_mfma_f32_16x16x32_bf16 a[104:107], v[88:91], v[168:171], a[104:107]
    v_perm_b32 v156, v121, v120, s31
    v_mfma_f32_16x16x32_bf16 a[108:111], v[88:91], v[172:175], a[108:111]
    v_perm_b32 v153, v123, v122, s30
    v_mfma_f32_16x16x32_bf16 a[112:115], v[92:95], v[160:163], a[112:115]
    v_perm_b32 v157, v123, v122, s31
    v_perm_b32 v154, v125, v124, s30
    v_mfma_f32_16x16x32_bf16 a[116:119], v[92:95], v[164:167], a[116:119]
    v_perm_b32 v158, v125, v124, s31
    v_mfma_f32_16x16x32_bf16 a[120:123], v[92:95], v[168:171], a[120:123]
    v_perm_b32 v155, v127, v126, s30
    v_mfma_f32_16x16x32_bf16 a[124:127], v[92:95], v[172:175], a[124:127]
    v_perm_b32 v159, v127, v126, s31
    s_waitcnt lgkmcnt(0)
    v_mfma_f32_16x16x32_bf16 a[0:3], v[32:35], v[144:147], a[0:3]
    s_add_u32 s36, s32, 4390912
    buffer_load_dword v112, v14, s[16:19], s36 offen
    v_mfma_f32_16x16x32_bf16 a[4:7], v[32:35], v[148:151], a[4:7]
    buffer_load_dword v113, v15, s[16:19], s36 offen
    v_mfma_f32_16x16x32_bf16 a[8:11], v[32:35], v[152:155], a[8:11]
    buffer_load_dword v114, v16, s[16:19], s36 offen
    v_mfma_f32_16x16x32_bf16 a[12:15], v[32:35], v[156:159], a[12:15]
    buffer_load_dword v115, v17, s[16:19], s36 offen
    buffer_load_dword v116, v18, s[16:19], s36 offen
    v_mfma_f32_16x16x32_bf16 a[16:19], v[36:39], v[144:147], a[16:19]
    buffer_load_dword v117, v19, s[16:19], s36 offen
    v_mfma_f32_16x16x32_bf16 a[20:23], v[36:39], v[148:151], a[20:23]
    buffer_load_dword v118, v20, s[16:19], s36 offen
    v_mfma_f32_16x16x32_bf16 a[24:27], v[36:39], v[152:155], a[24:27]
    buffer_load_dword v119, v21, s[16:19], s36 offen
    buffer_load_dword v120, v14, s[16:19], s36 offen offset:1024
    v_mfma_f32_16x16x32_bf16 a[28:31], v[36:39], v[156:159], a[28:31]
    buffer_load_dword v121, v15, s[16:19], s36 offen offset:1024
    v_mfma_f32_16x16x32_bf16 a[32:35], v[40:43], v[144:147], a[32:35]
    buffer_load_dword v122, v16, s[16:19], s36 offen offset:1024
    v_mfma_f32_16x16x32_bf16 a[36:39], v[40:43], v[148:151], a[36:39]
    buffer_load_dword v123, v17, s[16:19], s36 offen offset:1024
    buffer_load_dword v124, v18, s[16:19], s36 offen offset:1024
    v_mfma_f32_16x16x32_bf16 a[40:43], v[40:43], v[152:155], a[40:43]
    buffer_load_dword v125, v19, s[16:19], s36 offen offset:1024
    v_mfma_f32_16x16x32_bf16 a[44:47], v[40:43], v[156:159], a[44:47]
    buffer_load_dword v126, v20, s[16:19], s36 offen offset:1024
    v_mfma_f32_16x16x32_bf16 a[48:51], v[44:47], v[144:147], a[48:51]
    buffer_load_dword v127, v21, s[16:19], s36 offen offset:1024
    ds_read_b128 v[64:67], v11 offset:17408
    v_mfma_f32_16x16x32_bf16 a[52:55], v[44:47], v[148:151], a[52:55]
    ds_read_b128 v[68:71], v11 offset:19456
    v_mfma_f32_16x16x32_bf16 a[56:59], v[44:47], v[152:155], a[56:59]
    ds_read_b128 v[72:75], v11 offset:21504
    v_mfma_f32_16x16x32_bf16 a[60:63], v[44:47], v[156:159], a[60:63]
    ds_read_b128 v[76:79], v11 offset:23552
    v_mfma_f32_16x16x32_bf16 a[64:67], v[48:51], v[144:147], a[64:67]
    ds_read_b128 v[80:83], v11 offset:25600
    ds_read_b128 v[84:87], v11 offset:27648
    v_mfma_f32_16x16x32_bf16 a[68:71], v[48:51], v[148:151], a[68:71]
    ds_read_b128 v[88:91], v11 offset:29696
    v_mfma_f32_16x16x32_bf16 a[72:75], v[48:51], v[152:155], a[72:75]
    ds_read_b128 v[92:95], v11 offset:31744
    v_mfma_f32_16x16x32_bf16 a[76:79], v[48:51], v[156:159], a[76:79]
    s_waitcnt vmcnt(32)
    v_perm_b32 v160, v129, v128, s30
    v_mfma_f32_16x16x32_bf16 a[80:83], v[52:55], v[144:147], a[80:83]
    v_perm_b32 v164, v129, v128, s31
    v_mfma_f32_16x16x32_bf16 a[84:87], v[52:55], v[148:151], a[84:87]
    v_perm_b32 v161, v131, v130, s30
    v_mfma_f32_16x16x32_bf16 a[88:91], v[52:55], v[152:155], a[88:91]
    v_perm_b32 v165, v131, v130, s31
    v_perm_b32 v162, v133, v132, s30
    v_mfma_f32_16x16x32_bf16 a[92:95], v[52:55], v[156:159], a[92:95]
    v_perm_b32 v166, v133, v132, s31
    v_mfma_f32_16x16x32_bf16 a[96:99], v[56:59], v[144:147], a[96:99]
    v_perm_b32 v163, v135, v134, s30
    v_mfma_f32_16x16x32_bf16 a[100:103], v[56:59], v[148:151], a[100:103]
    v_perm_b32 v167, v135, v134, s31
    v_perm_b32 v168, v137, v136, s30
    v_mfma_f32_16x16x32_bf16 a[104:107], v[56:59], v[152:155], a[104:107]
    v_perm_b32 v172, v137, v136, s31
    v_mfma_f32_16x16x32_bf16 a[108:111], v[56:59], v[156:159], a[108:111]
    v_perm_b32 v169, v139, v138, s30
    v_mfma_f32_16x16x32_bf16 a[112:115], v[60:63], v[144:147], a[112:115]
    v_perm_b32 v173, v139, v138, s31
    v_perm_b32 v170, v141, v140, s30
    v_mfma_f32_16x16x32_bf16 a[116:119], v[60:63], v[148:151], a[116:119]
    v_perm_b32 v174, v141, v140, s31
    v_mfma_f32_16x16x32_bf16 a[120:123], v[60:63], v[152:155], a[120:123]
    v_perm_b32 v171, v143, v142, s30
    v_mfma_f32_16x16x32_bf16 a[124:127], v[60:63], v[156:159], a[124:127]
    v_perm_b32 v175, v143, v142, s31
    s_waitcnt lgkmcnt(0)
    v_mfma_f32_16x16x32_bf16 a[0:3], v[64:67], v[160:163], a[0:3]
    ds_read_b128 v[32:35], v12 offset:17408
    v_mfma_f32_16x16x32_bf16 a[4:7], v[64:67], v[164:167], a[4:7]
    ds_read_b128 v[36:39], v12 offset:19456
    v_mfma_f32_16x16x32_bf16 a[8:11], v[64:67], v[168:171], a[8:11]
    ds_read_b128 v[40:43], v12 offset:21504
    v_mfma_f32_16x16x32_bf16 a[12:15], v[64:67], v[172:175], a[12:15]
    ds_read_b128 v[44:47], v12 offset:23552
    v_mfma_f32_16x16x32_bf16 a[16:19], v[68:71], v[160:163], a[16:19]
    v_mfma_f32_16x16x32_bf16 a[20:23], v[68:71], v[164:167], a[20:23]
    ds_read_b128 v[48:51], v12 offset:25600
    v_mfma_f32_16x16x32_bf16 a[24:27], v[68:71], v[168:171], a[24:27]
    ds_read_b128 v[52:55], v12 offset:27648
    v_mfma_f32_16x16x32_bf16 a[28:31], v[68:71], v[172:175], a[28:31]
    ds_read_b128 v[56:59], v12 offset:29696
    v_mfma_f32_16x16x32_bf16 a[32:35], v[72:75], v[160:163], a[32:35]
    ds_read_b128 v[60:63], v12 offset:31744
    v_mfma_f32_16x16x32_bf16 a[36:39], v[72:75], v[164:167], a[36:39]
    v_mfma_f32_16x16x32_bf16 a[40:43], v[72:75], v[168:171], a[40:43]
    s_waitcnt vmcnt(16)
    v_mfma_f32_16x16x32_bf16 a[44:47], v[72:75], v[172:175], a[44:47]
    v_perm_b32 v144, v97, v96, s30
    v_mfma_f32_16x16x32_bf16 a[48:51], v[76:79], v[160:163], a[48:51]
    v_perm_b32 v148, v97, v96, s31
    v_mfma_f32_16x16x32_bf16 a[52:55], v[76:79], v[164:167], a[52:55]
    v_mfma_f32_16x16x32_bf16 a[56:59], v[76:79], v[168:171], a[56:59]
    v_perm_b32 v145, v99, v98, s30
    v_mfma_f32_16x16x32_bf16 a[60:63], v[76:79], v[172:175], a[60:63]
    v_perm_b32 v149, v99, v98, s31
    v_mfma_f32_16x16x32_bf16 a[64:67], v[80:83], v[160:163], a[64:67]
    v_perm_b32 v146, v101, v100, s30
    v_mfma_f32_16x16x32_bf16 a[68:71], v[80:83], v[164:167], a[68:71]
    v_perm_b32 v150, v101, v100, s31
    v_mfma_f32_16x16x32_bf16 a[72:75], v[80:83], v[168:171], a[72:75]
    v_mfma_f32_16x16x32_bf16 a[76:79], v[80:83], v[172:175], a[76:79]
    v_perm_b32 v147, v103, v102, s30
    v_mfma_f32_16x16x32_bf16 a[80:83], v[84:87], v[160:163], a[80:83]
    v_perm_b32 v151, v103, v102, s31
    v_mfma_f32_16x16x32_bf16 a[84:87], v[84:87], v[164:167], a[84:87]
    v_perm_b32 v152, v105, v104, s30
    v_mfma_f32_16x16x32_bf16 a[88:91], v[84:87], v[168:171], a[88:91]
    v_mfma_f32_16x16x32_bf16 a[92:95], v[84:87], v[172:175], a[92:95]
    v_perm_b32 v156, v105, v104, s31
    v_mfma_f32_16x16x32_bf16 a[96:99], v[88:91], v[160:163], a[96:99]
    v_perm_b32 v153, v107, v106, s30
    v_mfma_f32_16x16x32_bf16 a[100:103], v[88:91], v[164:167], a[100:103]
    v_perm_b32 v157, v107, v106, s31
    v_mfma_f32_16x16x32_bf16 a[104:107], v[88:91], v[168:171], a[104:107]
    v_perm_b32 v154, v109, v108, s30
    v_mfma_f32_16x16x32_bf16 a[108:111], v[88:91], v[172:175], a[108:111]
    v_mfma_f32_16x16x32_bf16 a[112:115], v[92:95], v[160:163], a[112:115]
    v_perm_b32 v158, v109, v108, s31
    v_mfma_f32_16x16x32_bf16 a[116:119], v[92:95], v[164:167], a[116:119]
    v_perm_b32 v155, v111, v110, s30
    v_mfma_f32_16x16x32_bf16 a[120:123], v[92:95], v[168:171], a[120:123]
    v_perm_b32 v159, v111, v110, s31
    v_mfma_f32_16x16x32_bf16 a[124:127], v[92:95], v[172:175], a[124:127]
    s_waitcnt lgkmcnt(0)
    v_mfma_f32_16x16x32_bf16 a[0:3], v[32:35], v[144:147], a[0:3]
    ds_read_b128 v[64:67], v13 offset:17408
    v_mfma_f32_16x16x32_bf16 a[4:7], v[32:35], v[148:151], a[4:7]
    ds_read_b128 v[68:71], v13 offset:19456
    v_mfma_f32_16x16x32_bf16 a[8:11], v[32:35], v[152:155], a[8:11]
    ds_read_b128 v[72:75], v13 offset:21504
    v_mfma_f32_16x16x32_bf16 a[12:15], v[32:35], v[156:159], a[12:15]
    ds_read_b128 v[76:79], v13 offset:23552
    v_mfma_f32_16x16x32_bf16 a[16:19], v[36:39], v[144:147], a[16:19]
    v_mfma_f32_16x16x32_bf16 a[20:23], v[36:39], v[148:151], a[20:23]
    ds_read_b128 v[80:83], v13 offset:25600
    v_mfma_f32_16x16x32_bf16 a[24:27], v[36:39], v[152:155], a[24:27]
    ds_read_b128 v[84:87], v13 offset:27648
    v_mfma_f32_16x16x32_bf16 a[28:31], v[36:39], v[156:159], a[28:31]
    ds_read_b128 v[88:91], v13 offset:29696
    v_mfma_f32_16x16x32_bf16 a[32:35], v[40:43], v[144:147], a[32:35]
    ds_read_b128 v[92:95], v13 offset:31744
    v_mfma_f32_16x16x32_bf16 a[36:39], v[40:43], v[148:151], a[36:39]
    v_mfma_f32_16x16x32_bf16 a[40:43], v[40:43], v[152:155], a[40:43]
    s_waitcnt vmcnt(0)
    v_mfma_f32_16x16x32_bf16 a[44:47], v[40:43], v[156:159], a[44:47]
    v_perm_b32 v160, v113, v112, s30
    v_mfma_f32_16x16x32_bf16 a[48:51], v[44:47], v[144:147], a[48:51]
    v_perm_b32 v164, v113, v112, s31
    v_mfma_f32_16x16x32_bf16 a[52:55], v[44:47], v[148:151], a[52:55]
    v_mfma_f32_16x16x32_bf16 a[56:59], v[44:47], v[152:155], a[56:59]
    v_perm_b32 v161, v115, v114, s30
    v_mfma_f32_16x16x32_bf16 a[60:63], v[44:47], v[156:159], a[60:63]
    v_perm_b32 v165, v115, v114, s31
    v_mfma_f32_16x16x32_bf16 a[64:67], v[48:51], v[144:147], a[64:67]
    v_perm_b32 v162, v117, v116, s30
    v_mfma_f32_16x16x32_bf16 a[68:71], v[48:51], v[148:151], a[68:71]
    v_perm_b32 v166, v117, v116, s31
    v_mfma_f32_16x16x32_bf16 a[72:75], v[48:51], v[152:155], a[72:75]
    v_mfma_f32_16x16x32_bf16 a[76:79], v[48:51], v[156:159], a[76:79]
    v_perm_b32 v163, v119, v118, s30
    v_mfma_f32_16x16x32_bf16 a[80:83], v[52:55], v[144:147], a[80:83]
    v_perm_b32 v167, v119, v118, s31
    v_mfma_f32_16x16x32_bf16 a[84:87], v[52:55], v[148:151], a[84:87]
    v_perm_b32 v168, v121, v120, s30
    v_mfma_f32_16x16x32_bf16 a[88:91], v[52:55], v[152:155], a[88:91]
    v_mfma_f32_16x16x32_bf16 a[92:95], v[52:55], v[156:159], a[92:95]
    v_perm_b32 v172, v121, v120, s31
    v_mfma_f32_16x16x32_bf16 a[96:99], v[56:59], v[144:147], a[96:99]
    v_perm_b32 v169, v123, v122, s30
    v_mfma_f32_16x16x32_bf16 a[100:103], v[56:59], v[148:151], a[100:103]
    v_perm_b32 v173, v123, v122, s31
    v_mfma_f32_16x16x32_bf16 a[104:107], v[56:59], v[152:155], a[104:107]
    v_perm_b32 v170, v125, v124, s30
    v_mfma_f32_16x16x32_bf16 a[108:111], v[56:59], v[156:159], a[108:111]
    v_mfma_f32_16x16x32_bf16 a[112:115], v[60:63], v[144:147], a[112:115]
    v_perm_b32 v174, v125, v124, s31
    v_mfma_f32_16x16x32_bf16 a[116:119], v[60:63], v[148:151], a[116:119]
    v_perm_b32 v171, v127, v126, s30
    v_mfma_f32_16x16x32_bf16 a[120:123], v[60:63], v[152:155], a[120:123]
    v_perm_b32 v175, v127, v126, s31
    v_mfma_f32_16x16x32_bf16 a[124:127], v[60:63], v[156:159], a[124:127]
    s_waitcnt lgkmcnt(0)
    v_mfma_f32_16x16x32_bf16 a[0:3], v[64:67], v[160:163], a[0:3]
    v_mfma_f32_16x16x32_bf16 a[4:7], v[64:67], v[164:167], a[4:7]
    v_mfma_f32_16x16x32_bf16 a[8:11], v[64:67], v[168:171], a[8:11]
    v_mfma_f32_16x16x32_bf16 a[12:15], v[64:67], v[172:175], a[12:15]
    v_mfma_f32_16x16x32_bf16 a[16:19], v[68:71], v[160:163], a[16:19]
    v_mfma_f32_16x16x32_bf16 a[20:23], v[68:71], v[164:167], a[20:23]
    v_mfma_f32_16x16x32_bf16 a[24:27], v[68:71], v[168:171], a[24:27]
    v_mfma_f32_16x16x32_bf16 a[28:31], v[68:71], v[172:175], a[28:31]
    v_mfma_f32_16x16x32_bf16 a[32:35], v[72:75], v[160:163], a[32:35]
    v_mfma_f32_16x16x32_bf16 a[36:39], v[72:75], v[164:167], a[36:39]
    v_mfma_f32_16x16x32_bf16 a[40:43], v[72:75], v[168:171], a[40:43]
    v_mfma_f32_16x16x32_bf16 a[44:47], v[72:75], v[172:175], a[44:47]
    v_mfma_f32_16x16x32_bf16 a[48:51], v[76:79], v[160:163], a[48:51]
    v_mfma_f32_16x16x32_bf16 a[52:55], v[76:79], v[164:167], a[52:55]
    v_mfma_f32_16x16x32_bf16 a[56:59], v[76:79], v[168:171], a[56:59]
    v_mfma_f32_16x16x32_bf16 a[60:63], v[76:79], v[172:175], a[60:63]
    v_mfma_f32_16x16x32_bf16 a[64:67], v[80:83], v[160:163], a[64:67]
    v_mfma_f32_16x16x32_bf16 a[68:71], v[80:83], v[164:167], a[68:71]
    v_mfma_f32_16x16x32_bf16 a[72:75], v[80:83], v[168:171], a[72:75]
    v_mfma_f32_16x16x32_bf16 a[76:79], v[80:83], v[172:175], a[76:79]
    v_mfma_f32_16x16x32_bf16 a[80:83], v[84:87], v[160:163], a[80:83]
    v_mfma_f32_16x16x32_bf16 a[84:87], v[84:87], v[164:167], a[84:87]
    v_mfma_f32_16x16x32_bf16 a[88:91], v[84:87], v[168:171], a[88:91]
    v_mfma_f32_16x16x32_bf16 a[92:95], v[84:87], v[172:175], a[92:95]
    v_mfma_f32_16x16x32_bf16 a[96:99], v[88:91], v[160:163], a[96:99]
    v_mfma_f32_16x16x32_bf16 a[100:103], v[88:91], v[164:167], a[100:103]
    v_mfma_f32_16x16x32_bf16 a[104:107], v[88:91], v[168:171], a[104:107]
    v_mfma_f32_16x16x32_bf16 a[108:111], v[88:91], v[172:175], a[108:111]
    v_mfma_f32_16x16x32_bf16 a[112:115], v[92:95], v[160:163], a[112:115]
    v_mfma_f32_16x16x32_bf16 a[116:119], v[92:95], v[164:167], a[116:119]
    v_mfma_f32_16x16x32_bf16 a[120:123], v[92:95], v[168:171], a[120:123]
    v_mfma_f32_16x16x32_bf16 a[124:127], v[92:95], v[172:175], a[124:127]
    s_nop 7
    s_nop 3
    v_add_u32 v2, s38, v26
    s_cmp_eq_u32 s29, 0
    s_cbranch_scc1 L_fin0
    s_cmp_eq_u32 s29, 1
    s_cbranch_scc1 L_fin1
    s_cmp_eq_u32 s29, 2
    s_cbranch_scc1 L_fin2
    s_branch L_fin3
L_fin0:
    ds_write_b128 v2, a[32:35] offset:8192
    ds_write_b128 v2, a[36:39] offset:9216
    ds_write_b128 v2, a[40:43] offset:10240
    ds_write_b128 v2, a[44:47] offset:11264
    ds_write_b128 v2, a[48:51] offset:12288
    ds_write_b128 v2, a[52:55] offset:13312
    ds_write_b128 v2, a[56:59] offset:14336
    ds_write_b128 v2, a[60:63] offset:15360
    ds_write_b128 v2, a[64:67] offset:16384
    ds_write_b128 v2, a[68:71] offset:17408
    ds_write_b128 v2, a[72:75] offset:18432
    ds_write_b128 v2, a[76:79] offset:19456
    ds_write_b128 v2, a[80:83] offset:20480
    ds_write_b128 v2, a[84:87] offset:21504
    ds_write_b128 v2, a[88:91] offset:22528
    ds_write_b128 v2, a[92:95] offset:23552
    ds_write_b128 v2, a[96:99] offset:24576
    ds_write_b128 v2, a[100:103] offset:25600
    ds_write_b128 v2, a[104:107] offset:26624
    ds_write_b128 v2, a[108:111] offset:27648
    ds_write_b128 v2, a[112:115] offset:28672
    ds_write_b128 v2, a[116:119] offset:29696
    ds_write_b128 v2, a[120:123] offset:30720
    ds_write_b128 v2, a[124:127] offset:31744
    v_add_u32 v27, 34816, v26
    v_add_u32 v28, 69632, v26
    v_add_u32 v29, 104448, v26
    v_accvgpr_read_b32 v128, a0
    v_accvgpr_read_b32 v129, a1
    v_accvgpr_read_b32 v130, a2
    v_accvgpr_read_b32 v131, a3
    v_accvgpr_read_b32 v132, a4
    v_accvgpr_read_b32 v133, a5
    v_accvgpr_read_b32 v134, a6
    v_accvgpr_read_b32 v135, a7
    v_accvgpr_read_b32 v136, a8
    v_accvgpr_read_b32 v137, a9
    v_accvgpr_read_b32 v138, a10
    v_accvgpr_read_b32 v139, a11
    v_accvgpr_read_b32 v140, a12
    v_accvgpr_read_b32 v141, a13
    v_accvgpr_read_b32 v142, a14
    v_accvgpr_read_b32 v143, a15
    v_accvgpr_read_b32 v144, a16
    v_accvgpr_read_b32 v145, a17
    v_accvgpr_read_b32 v146, a18
    v_accvgpr_read_b32 v147, a19
    v_accvgpr_read_b32 v148, a20
    v_accvgpr_read_b32 v149, a21
    v_accvgpr_read_b32 v150, a22
    v_accvgpr_read_b32 v151, a23
    v_accvgpr_read_b32 v152, a24
    v_accvgpr_read_b32 v153, a25
    v_accvgpr_read_b32 v154, a26
    v_accvgpr_read_b32 v155, a27
    v_accvgpr_read_b32 v156, a28
    v_accvgpr_read_b32 v157, a29
    v_accvgpr_read_b32 v158, a30
    v_accvgpr_read_b32 v159, a31
    s_waitcnt lgkmcnt(0)
    s_barrier
    ds_read_b128 v[32:35], v27 offset:0
    ds_read_b128 v[36:39], v27 offset:1024
    ds_read_b128 v[40:43], v27 offset:2048
    ds_read_b128 v[44:47], v27 offset:3072
    ds_read_b128 v[48:51], v27 offset:4096
    ds_read_b128 v[52:55], v27 offset:5120
    ds_read_b128 v[56:59], v27 offset:6144
    ds_read_b128 v[60:63], v27 offset:7168
    ds_read_b128 v[64:67], v28 offset:0
    ds_read_b128 v[68:71], v28 offset:1024
    ds_read_b128 v[72:75], v28 offset:2048
    ds_read_b128 v[76:79], v28 offset:3072
    s_waitcnt lgkmcnt(4)
    ds_read_b128 v[80:83], v28 offset:4096
    ds_read_b128 v[84:87], v28 offset:5120
    ds_read_b128 v[88:91], v28 offset:6144
    ds_read_b128 v[92:95], v28 offset:7168
    ds_read_b128 v[96:99], v29 offset:0
    ds_read_b128 v[100:103], v29 offset:1024
    ds_read_b128 v[104:107], v29 offset:2048
    ds_read_b128 v[108:111], v29 offset:3072
    v_add_f32 v128, v128, v32
    v_add_f32 v129, v129, v33
    v_add_f32 v130, v130, v34
    v_add_f32 v131, v131, v35
    v_add_f32 v132, v132, v36
    v_add_f32 v133, v133, v37
    v_add_f32 v134, v134, v38
    v_add_f32 v135, v135, v39
    v_add_f32 v136, v136, v40
    v_add_f32 v137, v137, v41
    v_add_f32 v138, v138, v42
    v_add_f32 v139, v139, v43
    v_add_f32 v140, v140, v44
    v_add_f32 v141, v141, v45
    v_add_f32 v142, v142, v46
    v_add_f32 v143, v143, v47
    v_add_f32 v144, v144, v48
    v_add_f32 v145, v145, v49
    v_add_f32 v146, v146, v50
    v_add_f32 v147, v147, v51
    v_add_f32 v148, v148, v52
    v_add_f32 v149, v149, v53
    v_add_f32 v150, v150, v54
    v_add_f32 v151, v151, v55
    v_add_f32 v152, v152, v56
    v_add_f32 v153, v153, v57
    v_add_f32 v154, v154, v58
    v_add_f32 v155, v155, v59
    v_add_f32 v156, v156, v60
    v_add_f32 v157, v157, v61
    v_add_f32 v158, v158, v62
    v_add_f32 v159, v159, v63
    s_waitcnt lgkmcnt(4)
    ds_read_b128 v[112:115], v29 offset:4096
    ds_read_b128 v[116:119], v29 offset:5120
    ds_read_b128 v[120:123], v29 offset:6144
    ds_read_b128 v[124:127], v29 offset:7168
    v_add_f32 v128, v128, v64
    v_add_f32 v129, v129, v65
    v_add_f32 v130, v130, v66
    v_add_f32 v131, v131, v67
    v_add_f32 v132, v132, v68
    v_add_f32 v133, v133, v69
    v_add_f32 v134, v134, v70
    v_add_f32 v135, v135, v71
    v_add_f32 v136, v136, v72
    v_add_f32 v137, v137, v73
    v_add_f32 v138, v138, v74
    v_add_f32 v139, v139, v75
    v_add_f32 v140, v140, v76
    v_add_f32 v141, v141, v77
    v_add_f32 v142, v142, v78
    v_add_f32 v143, v143, v79
    v_add_f32 v144, v144, v80
    v_add_f32 v145, v145, v81
    v_add_f32 v146, v146, v82
    v_add_f32 v147, v147, v83
    v_add_f32 v148, v148, v84
    v_add_f32 v149, v149, v85
    v_add_f32 v150, v150, v86
    v_add_f32 v151, v151, v87
    v_add_f32 v152, v152, v88
    v_add_f32 v153, v153, v89
    v_add_f32 v154, v154, v90
    v_add_f32 v155, v155, v91
    v_add_f32 v156, v156, v92
    v_add_f32 v157, v157, v93
    v_add_f32 v158, v158, v94
    v_add_f32 v159, v159, v95
    s_waitcnt lgkmcnt(0)
    v_add_f32 v128, v128, v96
    v_add_f32 v129, v129, v97
    v_add_f32 v130, v130, v98
    v_add_f32 v131, v131, v99
    v_add_f32 v132, v132, v100
    v_add_f32 v133, v133, v101
    v_add_f32 v134, v134, v102
    v_add_f32 v135, v135, v103
    v_add_f32 v136, v136, v104
    v_add_f32 v137, v137, v105
    v_add_f32 v138, v138, v106
    v_add_f32 v139, v139, v107
    v_add_f32 v140, v140, v108
    v_add_f32 v141, v141, v109
    v_add_f32 v142, v142, v110
    v_add_f32 v143, v143, v111
    v_add_f32 v144, v144, v112
    v_add_f32 v145, v145, v113
    v_add_f32 v146, v146, v114
    v_add_f32 v147, v147, v115
    v_add_f32 v148, v148, v116
    v_add_f32 v149, v149, v117
    v_add_f32 v150, v150, v118
    v_add_f32 v151, v151, v119
    v_add_f32 v152, v152, v120
    v_add_f32 v153, v153, v121
    v_add_f32 v154, v154, v122
    v_add_f32 v155, v155, v123
    v_add_f32 v156, v156, v124
    v_add_f32 v157, v157, v125
    v_add_f32 v158, v158, v126
    v_add_f32 v159, v159, v127
    v_mul_f32 v32, s41, v128
    v_mul_f32 v33, s42, v136
    v_mul_f32 v34, s41, v132
    v_mul_f32 v35, s42, v140
    v_mul_f32 v36, s41, v129
    v_mul_f32 v37, s42, v137
    v_mul_f32 v38, s41, v133
    v_mul_f32 v39, s42, v141
    v_mul_f32 v40, s41, v130
    v_mul_f32 v41, s42, v138
    v_mul_f32 v42, s41, v134
    v_mul_f32 v43, s42, v142
    v_mul_f32 v44, s41, v131
    v_mul_f32 v45, s42, v139
    v_mul_f32 v46, s41, v135
    v_mul_f32 v47, s42, v143
    v_mul_f32 v48, s41, v144
    v_mul_f32 v49, s42, v152
    v_mul_f32 v50, s41, v148
    v_mul_f32 v51, s42, v156
    v_mul_f32 v52, s41, v145
    v_mul_f32 v53, s42, v153
    v_mul_f32 v54, s41, v149
    v_mul_f32 v55, s42, v157
    v_mul_f32 v56, s41, v146
    v_mul_f32 v57, s42, v154
    v_mul_f32 v58, s41, v150
    v_mul_f32 v59, s42, v158
    v_mul_f32 v60, s41, v147
    v_mul_f32 v61, s42, v155
    v_mul_f32 v62, s41, v151
    v_mul_f32 v63, s42, v159
    v_exp_f32 v32, v32
    v_exp_f32 v33, v33
    v_exp_f32 v34, v34
    v_exp_f32 v35, v35
    v_exp_f32 v36, v36
    v_exp_f32 v37, v37
    v_exp_f32 v38, v38
    v_exp_f32 v39, v39
    v_exp_f32 v40, v40
    v_exp_f32 v41, v41
    v_exp_f32 v42, v42
    v_exp_f32 v43, v43
    v_exp_f32 v44, v44
    v_exp_f32 v45, v45
    v_exp_f32 v46, v46
    v_exp_f32 v47, v47
    v_exp_f32 v48, v48
    v_exp_f32 v49, v49
    v_exp_f32 v50, v50
    v_exp_f32 v51, v51
    v_exp_f32 v52, v52
    v_exp_f32 v53, v53
    v_exp_f32 v54, v54
    v_exp_f32 v55, v55
    v_exp_f32 v56, v56
    v_exp_f32 v57, v57
    v_exp_f32 v58, v58
    v_exp_f32 v59, v59
    v_exp_f32 v60, v60
    v_exp_f32 v61, v61
    v_exp_f32 v62, v62
    v_exp_f32 v63, v63
    v_add_f32 v32, 1.0, v32
    v_add_f32 v33, 1.0, v33
    v_add_f32 v34, 1.0, v34
    v_add_f32 v35, 1.0, v35
    v_add_f32 v36, 1.0, v36
    v_add_f32 v37, 1.0, v37
    v_add_f32 v38, 1.0, v38
    v_add_f32 v39, 1.0, v39
    v_add_f32 v40, 1.0, v40
    v_add_f32 v41, 1.0, v41
    v_add_f32 v42, 1.0, v42
    v_add_f32 v43, 1.0, v43
    v_add_f32 v44, 1.0, v44
    v_add_f32 v45, 1.0, v45
    v_add_f32 v46, 1.0, v46
    v_add_f32 v47, 1.0, v47
    v_add_f32 v48, 1.0, v48
    v_add_f32 v49, 1.0, v49
    v_add_f32 v50, 1.0, v50
    v_add_f32 v51, 1.0, v51
    v_add_f32 v52, 1.0, v52
    v_add_f32 v53, 1.0, v53
    v_add_f32 v54, 1.0, v54
    v_add_f32 v55, 1.0, v55
    v_add_f32 v56, 1.0, v56
    v_add_f32 v57, 1.0, v57
    v_add_f32 v58, 1.0, v58
    v_add_f32 v59, 1.0, v59
    v_add_f32 v60, 1.0, v60
    v_add_f32 v61, 1.0, v61
    v_add_f32 v62, 1.0, v62
    v_add_f32 v63, 1.0, v63
    v_rcp_f32 v32, v32
    v_rcp_f32 v33, v33
    v_rcp_f32 v34, v34
    v_rcp_f32 v35, v35
    v_rcp_f32 v36, v36
    v_rcp_f32 v37, v37
    v_rcp_f32 v38, v38
    v_rcp_f32 v39, v39
    v_rcp_f32 v40, v40
    v_rcp_f32 v41, v41
    v_rcp_f32 v42, v42
    v_rcp_f32 v43, v43
    v_rcp_f32 v44, v44
    v_rcp_f32 v45, v45
    v_rcp_f32 v46, v46
    v_rcp_f32 v47, v47
    v_rcp_f32 v48, v48
    v_rcp_f32 v49, v49
    v_rcp_f32 v50, v50
    v_rcp_f32 v51, v51
    v_rcp_f32 v52, v52
    v_rcp_f32 v53, v53
    v_rcp_f32 v54, v54
    v_rcp_f32 v55, v55
    v_rcp_f32 v56, v56
    v_rcp_f32 v57, v57
    v_rcp_f32 v58, v58
    v_rcp_f32 v59, v59
    v_rcp_f32 v60, v60
    v_rcp_f32 v61, v61
    v_rcp_f32 v62, v62
    v_rcp_f32 v63, v63
    v_fma_f32 v32, v32, -2.0, 1.0
    v_fma_f32 v34, v34, -2.0, 1.0
    v_fma_f32 v36, v36, -2.0, 1.0
    v_fma_f32 v38, v38, -2.0, 1.0
    v_fma_f32 v40, v40, -2.0, 1.0
    v_fma_f32 v42, v42, -2.0, 1.0
    v_fma_f32 v44, v44, -2.0, 1.0
    v_fma_f32 v46, v46, -2.0, 1.0
    v_fma_f32 v48, v48, -2.0, 1.0
    v_fma_f32 v50, v50, -2.0, 1.0
    v_fma_f32 v52, v52, -2.0, 1.0
    v_fma_f32 v54, v54, -2.0, 1.0
    v_fma_f32 v56, v56, -2.0, 1.0
    v_fma_f32 v58, v58, -2.0, 1.0
    v_fma_f32 v60, v60, -2.0, 1.0
    v_fma_f32 v62, v62, -2.0, 1.0
    v_mul_f32 v32, v32, v33
    v_mul_f32 v34, v34, v35
    v_mul_f32 v36, v36, v37
    v_mul_f32 v38, v38, v39
    v_mul_f32 v40, v40, v41
    v_mul_f32 v42, v42, v43
    v_mul_f32 v44, v44, v45
    v_mul_f32 v46, v46, v47
    v_mul_f32 v48, v48, v49
    v_mul_f32 v50, v50, v51
    v_mul_f32 v52, v52, v53
    v_mul_f32 v54, v54, v55
    v_mul_f32 v56, v56, v57
    v_mul_f32 v58, v58, v59
    v_mul_f32 v60, v60, v61
    v_mul_f32 v62, v62, v63
    s_mov_b32 s40, 0
    s_mov_b32 s43, 16384
    v_cvt_pk_bf16_f32 v64, v32, v34
    v_cvt_pk_bf16_f32 v65, v36, v38
    v_cvt_pk_bf16_f32 v66, v40, v42
    v_cvt_pk_bf16_f32 v67, v44, v46
    v_cvt_pk_bf16_f32 v68, v48, v50
    v_cvt_pk_bf16_f32 v69, v52, v54
    v_cvt_pk_bf16_f32 v70, v56, v58
    v_cvt_pk_bf16_f32 v71, v60, v62
    buffer_store_dword v64, v25, s[20:23], s40 offen
    buffer_store_dword v65, v25, s[20:23], s40 offen offset:1024
    buffer_store_dword v66, v25, s[20:23], s40 offen offset:2048
    buffer_store_dword v67, v25, s[20:23], s40 offen offset:3072
    buffer_store_dword v68, v25, s[20:23], s43 offen
    buffer_store_dword v69, v25, s[20:23], s43 offen offset:1024
    buffer_store_dword v70, v25, s[20:23], s43 offen offset:2048
    buffer_store_dword v71, v25, s[20:23], s43 offen offset:3072
    s_endpgm
L_fin1:
    ds_write_b128 v2, a[0:3] offset:0
    ds_write_b128 v2, a[4:7] offset:1024
    ds_write_b128 v2, a[8:11] offset:2048
    ds_write_b128 v2, a[12:15] offset:3072
    ds_write_b128 v2, a[16:19] offset:4096
    ds_write_b128 v2, a[20:23] offset:5120
    ds_write_b128 v2, a[24:27] offset:6144
    ds_write_b128 v2, a[28:31] offset:7168
    ds_write_b128 v2, a[64:67] offset:16384
    ds_write_b128 v2, a[68:71] offset:17408
    ds_write_b128 v2, a[72:75] offset:18432
    ds_write_b128 v2, a[76:79] offset:19456
    ds_write_b128 v2, a[80:83] offset:20480
    ds_write_b128 v2, a[84:87] offset:21504
    ds_write_b128 v2, a[88:91] offset:22528
    ds_write_b128 v2, a[92:95] offset:23552
    ds_write_b128 v2, a[96:99] offset:24576
    ds_write_b128 v2, a[100:103] offset:25600
    ds_write_b128 v2, a[104:107] offset:26624
    ds_write_b128 v2, a[108:111] offset:27648
    ds_write_b128 v2, a[112:115] offset:28672
    ds_write_b128 v2, a[116:119] offset:29696
    ds_write_b128 v2, a[120:123] offset:30720
    ds_write_b128 v2, a[124:127] offset:31744
    v_add_u32 v27, 8192, v26
    v_add_u32 v28, 77824, v26
    v_add_u32 v29, 112640, v26
    v_accvgpr_read_b32 v128, a32
    v_accvgpr_read_b32 v129, a33
    v_accvgpr_read_b32 v130, a34
    v_accvgpr_read_b32 v131, a35
    v_accvgpr_read_b32 v132, a36
    v_accvgpr_read_b32 v133, a37
    v_accvgpr_read_b32 v134, a38
    v_accvgpr_read_b32 v135, a39
    v_accvgpr_read_b32 v136, a40
    v_accvgpr_read_b32 v137, a41
    v_accvgpr_read_b32 v138, a42
    v_accvgpr_read_b32 v139, a43
    v_accvgpr_read_b32 v140, a44
    v_accvgpr_read_b32 v141, a45
    v_accvgpr_read_b32 v142, a46
    v_accvgpr_read_b32 v143, a47
    v_accvgpr_read_b32 v144, a48
    v_accvgpr_read_b32 v145, a49
    v_accvgpr_read_b32 v146, a50
    v_accvgpr_read_b32 v147, a51
    v_accvgpr_read_b32 v148, a52
    v_accvgpr_read_b32 v149, a53
    v_accvgpr_read_b32 v150, a54
    v_accvgpr_read_b32 v151, a55
    v_accvgpr_read_b32 v152, a56
    v_accvgpr_read_b32 v153, a57
    v_accvgpr_read_b32 v154, a58
    v_accvgpr_read_b32 v155, a59
    v_accvgpr_read_b32 v156, a60
    v_accvgpr_read_b32 v157, a61
    v_accvgpr_read_b32 v158, a62
    v_accvgpr_read_b32 v159, a63
    s_waitcnt lgkmcnt(0)
    s_barrier
    ds_read_b128 v[32:35], v27 offset:0
    ds_read_b128 v[36:39], v27 offset:1024
    ds_read_b128 v[40:43], v27 offset:2048
    ds_read_b128 v[44:47], v27 offset:3072
    ds_read_b128 v[48:51], v27 offset:4096
    ds_read_b128 v[52:55], v27 offset:5120
    ds_read_b128 v[56:59], v27 offset:6144
    ds_read_b128 v[60:63], v27 offset:7168
    ds_read_b128 v[64:67], v28 offset:0
    ds_read_b128 v[68:71], v28 offset:1024
    ds_read_b128 v[72:75], v28 offset:2048
    ds_read_b128 v[76:79], v28 offset:3072
    s_waitcnt lgkmcnt(4)
    ds_read_b128 v[80:83], v28 offset:4096
    ds_read_b128 v[84:87], v28 offset:5120
    ds_read_b128 v[88:91], v28 offset:6144
    ds_read_b128 v[92:95], v28 offset:7168
    ds_read_b128 v[96:99], v29 offset:0
    ds_read_b128 v[100:103], v29 offset:1024
    ds_read_b128 v[104:107], v29 offset:2048
    ds_read_b128 v[108:111], v29 offset:3072
    v_add_f32 v128, v128, v32
    v_add_f32 v129, v129, v33
    v_add_f32 v130, v130, v34
    v_add_f32 v131, v131, v35
    v_add_f32 v132, v132, v36
    v_add_f32 v133, v133, v37
    v_add_f32 v134, v134, v38
    v_add_f32 v135, v135, v39
    v_add_f32 v136, v136, v40
    v_add_f32 v137, v137, v41
    v_add_f32 v138, v138, v42
    v_add_f32 v139, v139, v43
    v_add_f32 v140, v140, v44
    v_add_f32 v141, v141, v45
    v_add_f32 v142, v142, v46
    v_add_f32 v143, v143, v47
    v_add_f32 v144, v144, v48
    v_add_f32 v145, v145, v49
    v_add_f32 v146, v146, v50
    v_add_f32 v147, v147, v51
    v_add_f32 v148, v148, v52
    v_add_f32 v149, v149, v53
    v_add_f32 v150, v150, v54
    v_add_f32 v151, v151, v55
    v_add_f32 v152, v152, v56
    v_add_f32 v153, v153, v57
    v_add_f32 v154, v154, v58
    v_add_f32 v155, v155, v59
    v_add_f32 v156, v156, v60
    v_add_f32 v157, v157, v61
    v_add_f32 v158, v158, v62
    v_add_f32 v159, v159, v63
    s_waitcnt lgkmcnt(4)
    ds_read_b128 v[112:115], v29 offset:4096
    ds_read_b128 v[116:119], v29 offset:5120
    ds_read_b128 v[120:123], v29 offset:6144
    ds_read_b128 v[124:127], v29 offset:7168
    v_add_f32 v128, v128, v64
    v_add_f32 v129, v129, v65
    v_add_f32 v130, v130, v66
    v_add_f32 v131, v131, v67
    v_add_f32 v132, v132, v68
    v_add_f32 v133, v133, v69
    v_add_f32 v134, v134, v70
    v_add_f32 v135, v135, v71
    v_add_f32 v136, v136, v72
    v_add_f32 v137, v137, v73
    v_add_f32 v138, v138, v74
    v_add_f32 v139, v139, v75
    v_add_f32 v140, v140, v76
    v_add_f32 v141, v141, v77
    v_add_f32 v142, v142, v78
    v_add_f32 v143, v143, v79
    v_add_f32 v144, v144, v80
    v_add_f32 v145, v145, v81
    v_add_f32 v146, v146, v82
    v_add_f32 v147, v147, v83
    v_add_f32 v148, v148, v84
    v_add_f32 v149, v149, v85
    v_add_f32 v150, v150, v86
    v_add_f32 v151, v151, v87
    v_add_f32 v152, v152, v88
    v_add_f32 v153, v153, v89
    v_add_f32 v154, v154, v90
    v_add_f32 v155, v155, v91
    v_add_f32 v156, v156, v92
    v_add_f32 v157, v157, v93
    v_add_f32 v158, v158, v94
    v_add_f32 v159, v159, v95
    s_waitcnt lgkmcnt(0)
    v_add_f32 v128, v128, v96
    v_add_f32 v129, v129, v97
    v_add_f32 v130, v130, v98
    v_add_f32 v131, v131, v99
    v_add_f32 v132, v132, v100
    v_add_f32 v133, v133, v101
    v_add_f32 v134, v134, v102
    v_add_f32 v135, v135, v103
    v_add_f32 v136, v136, v104
    v_add_f32 v137, v137, v105
    v_add_f32 v138, v138, v106
    v_add_f32 v139, v139, v107
    v_add_f32 v140, v140, v108
    v_add_f32 v141, v141, v109
    v_add_f32 v142, v142, v110
    v_add_f32 v143, v143, v111
    v_add_f32 v144, v144, v112
    v_add_f32 v145, v145, v113
    v_add_f32 v146, v146, v114
    v_add_f32 v147, v147, v115
    v_add_f32 v148, v148, v116
    v_add_f32 v149, v149, v117
    v_add_f32 v150, v150, v118
    v_add_f32 v151, v151, v119
    v_add_f32 v152, v152, v120
    v_add_f32 v153, v153, v121
    v_add_f32 v154, v154, v122
    v_add_f32 v155, v155, v123
    v_add_f32 v156, v156, v124
    v_add_f32 v157, v157, v125
    v_add_f32 v158, v158, v126
    v_add_f32 v159, v159, v127
    v_mul_f32 v32, s41, v128
    v_mul_f32 v33, s42, v136
    v_mul_f32 v34, s41, v132
    v_mul_f32 v35, s42, v140
    v_mul_f32 v36, s41, v129
    v_mul_f32 v37, s42, v137
    v_mul_f32 v38, s41, v133
    v_mul_f32 v39, s42, v141
    v_mul_f32 v40, s41, v130
    v_mul_f32 v41, s42, v138
    v_mul_f32 v42, s41, v134
    v_mul_f32 v43, s42, v142
    v_mul_f32 v44, s41, v131
    v_mul_f32 v45, s42, v139
    v_mul_f32 v46, s41, v135
    v_mul_f32 v47, s42, v143
    v_mul_f32 v48, s41, v144
    v_mul_f32 v49, s42, v152
    v_mul_f32 v50, s41, v148
    v_mul_f32 v51, s42, v156
    v_mul_f32 v52, s41, v145
    v_mul_f32 v53, s42, v153
    v_mul_f32 v54, s41, v149
    v_mul_f32 v55, s42, v157
    v_mul_f32 v56, s41, v146
    v_mul_f32 v57, s42, v154
    v_mul_f32 v58, s41, v150
    v_mul_f32 v59, s42, v158
    v_mul_f32 v60, s41, v147
    v_mul_f32 v61, s42, v155
    v_mul_f32 v62, s41, v151
    v_mul_f32 v63, s42, v159
    v_exp_f32 v32, v32
    v_exp_f32 v33, v33
    v_exp_f32 v34, v34
    v_exp_f32 v35, v35
    v_exp_f32 v36, v36
    v_exp_f32 v37, v37
    v_exp_f32 v38, v38
    v_exp_f32 v39, v39
    v_exp_f32 v40, v40
    v_exp_f32 v41, v41
    v_exp_f32 v42, v42
    v_exp_f32 v43, v43
    v_exp_f32 v44, v44
    v_exp_f32 v45, v45
    v_exp_f32 v46, v46
    v_exp_f32 v47, v47
    v_exp_f32 v48, v48
    v_exp_f32 v49, v49
    v_exp_f32 v50, v50
    v_exp_f32 v51, v51
    v_exp_f32 v52, v52
    v_exp_f32 v53, v53
    v_exp_f32 v54, v54
    v_exp_f32 v55, v55
    v_exp_f32 v56, v56
    v_exp_f32 v57, v57
    v_exp_f32 v58, v58
    v_exp_f32 v59, v59
    v_exp_f32 v60, v60
    v_exp_f32 v61, v61
    v_exp_f32 v62, v62
    v_exp_f32 v63, v63
    v_add_f32 v32, 1.0, v32
    v_add_f32 v33, 1.0, v33
    v_add_f32 v34, 1.0, v34
    v_add_f32 v35, 1.0, v35
    v_add_f32 v36, 1.0, v36
    v_add_f32 v37, 1.0, v37
    v_add_f32 v38, 1.0, v38
    v_add_f32 v39, 1.0, v39
    v_add_f32 v40, 1.0, v40
    v_add_f32 v41, 1.0, v41
    v_add_f32 v42, 1.0, v42
    v_add_f32 v43, 1.0, v43
    v_add_f32 v44, 1.0, v44
    v_add_f32 v45, 1.0, v45
    v_add_f32 v46, 1.0, v46
    v_add_f32 v47, 1.0, v47
    v_add_f32 v48, 1.0, v48
    v_add_f32 v49, 1.0, v49
    v_add_f32 v50, 1.0, v50
    v_add_f32 v51, 1.0, v51
    v_add_f32 v52, 1.0, v52
    v_add_f32 v53, 1.0, v53
    v_add_f32 v54, 1.0, v54
    v_add_f32 v55, 1.0, v55
    v_add_f32 v56, 1.0, v56
    v_add_f32 v57, 1.0, v57
    v_add_f32 v58, 1.0, v58
    v_add_f32 v59, 1.0, v59
    v_add_f32 v60, 1.0, v60
    v_add_f32 v61, 1.0, v61
    v_add_f32 v62, 1.0, v62
    v_add_f32 v63, 1.0, v63
    v_rcp_f32 v32, v32
    v_rcp_f32 v33, v33
    v_rcp_f32 v34, v34
    v_rcp_f32 v35, v35
    v_rcp_f32 v36, v36
    v_rcp_f32 v37, v37
    v_rcp_f32 v38, v38
    v_rcp_f32 v39, v39
    v_rcp_f32 v40, v40
    v_rcp_f32 v41, v41
    v_rcp_f32 v42, v42
    v_rcp_f32 v43, v43
    v_rcp_f32 v44, v44
    v_rcp_f32 v45, v45
    v_rcp_f32 v46, v46
    v_rcp_f32 v47, v47
    v_rcp_f32 v48, v48
    v_rcp_f32 v49, v49
    v_rcp_f32 v50, v50
    v_rcp_f32 v51, v51
    v_rcp_f32 v52, v52
    v_rcp_f32 v53, v53
    v_rcp_f32 v54, v54
    v_rcp_f32 v55, v55
    v_rcp_f32 v56, v56
    v_rcp_f32 v57, v57
    v_rcp_f32 v58, v58
    v_rcp_f32 v59, v59
    v_rcp_f32 v60, v60
    v_rcp_f32 v61, v61
    v_rcp_f32 v62, v62
    v_rcp_f32 v63, v63
    v_fma_f32 v32, v32, -2.0, 1.0
    v_fma_f32 v34, v34, -2.0, 1.0
    v_fma_f32 v36, v36, -2.0, 1.0
    v_fma_f32 v38, v38, -2.0, 1.0
    v_fma_f32 v40, v40, -2.0, 1.0
    v_fma_f32 v42, v42, -2.0, 1.0
    v_fma_f32 v44, v44, -2.0, 1.0
    v_fma_f32 v46, v46, -2.0, 1.0
    v_fma_f32 v48, v48, -2.0, 1.0
    v_fma_f32 v50, v50, -2.0, 1.0
    v_fma_f32 v52, v52, -2.0, 1.0
    v_fma_f32 v54, v54, -2.0, 1.0
    v_fma_f32 v56, v56, -2.0, 1.0
    v_fma_f32 v58, v58, -2.0, 1.0
    v_fma_f32 v60, v60, -2.0, 1.0
    v_fma_f32 v62, v62, -2.0, 1.0
    v_mul_f32 v32, v32, v33
    v_mul_f32 v34, v34, v35
    v_mul_f32 v36, v36, v37
    v_mul_f32 v38, v38, v39
    v_mul_f32 v40, v40, v41
    v_mul_f32 v42, v42, v43
    v_mul_f32 v44, v44, v45
    v_mul_f32 v46, v46, v47
    v_mul_f32 v48, v48, v49
    v_mul_f32 v50, v50, v51
    v_mul_f32 v52, v52, v53
    v_mul_f32 v54, v54, v55
    v_mul_f32 v56, v56, v57
    v_mul_f32 v58, v58, v59
    v_mul_f32 v60, v60, v61
    v_mul_f32 v62, v62, v63
    s_mov_b32 s40, 32768
    s_mov_b32 s43, 49152
    v_cvt_pk_bf16_f32 v64, v32, v34
    v_cvt_pk_bf16_f32 v65, v36, v38
    v_cvt_pk_bf16_f32 v66, v40, v42
    v_cvt_pk_bf16_f32 v67, v44, v46
    v_cvt_pk_bf16_f32 v68, v48, v50
    v_cvt_pk_bf16_f32 v69, v52, v54
    v_cvt_pk_bf16_f32 v70, v56, v58
    v_cvt_pk_bf16_f32 v71, v60, v62
    buffer_store_dword v64, v25, s[20:23], s40 offen
    buffer_store_dword v65, v25, s[20:23], s40 offen offset:1024
    buffer_store_dword v66, v25, s[20:23], s40 offen offset:2048
    buffer_store_dword v67, v25, s[20:23], s40 offen offset:3072
    buffer_store_dword v68, v25, s[20:23], s43 offen
    buffer_store_dword v69, v25, s[20:23], s43 offen offset:1024
    buffer_store_dword v70, v25, s[20:23], s43 offen offset:2048
    buffer_store_dword v71, v25, s[20:23], s43 offen offset:3072
    s_endpgm
L_fin2:
    ds_write_b128 v2, a[0:3] offset:0
    ds_write_b128 v2, a[4:7] offset:1024
    ds_write_b128 v2, a[8:11] offset:2048
    ds_write_b128 v2, a[12:15] offset:3072
    ds_write_b128 v2, a[16:19] offset:4096
    ds_write_b128 v2, a[20:23] offset:5120
    ds_write_b128 v2, a[24:27] offset:6144
    ds_write_b128 v2, a[28:31] offset:7168
    ds_write_b128 v2, a[32:35] offset:8192
    ds_write_b128 v2, a[36:39] offset:9216
    ds_write_b128 v2, a[40:43] offset:10240
    ds_write_b128 v2, a[44:47] offset:11264
    ds_write_b128 v2, a[48:51] offset:12288
    ds_write_b128 v2, a[52:55] offset:13312
    ds_write_b128 v2, a[56:59] offset:14336
    ds_write_b128 v2, a[60:63] offset:15360
    ds_write_b128 v2, a[96:99] offset:24576
    ds_write_b128 v2, a[100:103] offset:25600
    ds_write_b128 v2, a[104:107] offset:26624
    ds_write_b128 v2, a[108:111] offset:27648
    ds_write_b128 v2, a[112:115] offset:28672
    ds_write_b128 v2, a[116:119] offset:29696
    ds_write_b128 v2, a[120:123] offset:30720
    ds_write_b128 v2, a[124:127] offset:31744
    v_add_u32 v27, 16384, v26
    v_add_u32 v28, 51200, v26
    v_add_u32 v29, 120832, v26
    v_accvgpr_read_b32 v128, a64
    v_accvgpr_read_b32 v129, a65
    v_accvgpr_read_b32 v130, a66
    v_accvgpr_read_b32 v131, a67
    v_accvgpr_read_b32 v132, a68
    v_accvgpr_read_b32 v133, a69
    v_accvgpr_read_b32 v134, a70
    v_accvgpr_read_b32 v135, a71
    v_accvgpr_read_b32 v136, a72
    v_accvgpr_read_b32 v137, a73
    v_accvgpr_read_b32 v138, a74
    v_accvgpr_read_b32 v139, a75
    v_accvgpr_read_b32 v140, a76
    v_accvgpr_read_b32 v141, a77
    v_accvgpr_read_b32 v142, a78
    v_accvgpr_read_b32 v143, a79
    v_accvgpr_read_b32 v144, a80
    v_accvgpr_read_b32 v145, a81
    v_accvgpr_read_b32 v146, a82
    v_accvgpr_read_b32 v147, a83
    v_accvgpr_read_b32 v148, a84
    v_accvgpr_read_b32 v149, a85
    v_accvgpr_read_b32 v150, a86
    v_accvgpr_read_b32 v151, a87
    v_accvgpr_read_b32 v152, a88
    v_accvgpr_read_b32 v153, a89
    v_accvgpr_read_b32 v154, a90
    v_accvgpr_read_b32 v155, a91
    v_accvgpr_read_b32 v156, a92
    v_accvgpr_read_b32 v157, a93
    v_accvgpr_read_b32 v158, a94
    v_accvgpr_read_b32 v159, a95
    s_waitcnt lgkmcnt(0)
    s_barrier
    ds_read_b128 v[32:35], v27 offset:0
    ds_read_b128 v[36:39], v27 offset:1024
    ds_read_b128 v[40:43], v27 offset:2048
    ds_read_b128 v[44:47], v27 offset:3072
    ds_read_b128 v[48:51], v27 offset:4096
    ds_read_b128 v[52:55], v27 offset:5120
    ds_read_b128 v[56:59], v27 offset:6144
    ds_read_b128 v[60:63], v27 offset:7168
    ds_read_b128 v[64:67], v28 offset:0
    ds_read_b128 v[68:71], v28 offset:1024
    ds_read_b128 v[72:75], v28 offset:2048
    ds_read_b128 v[76:79], v28 offset:3072
    s_waitcnt lgkmcnt(4)
    ds_read_b128 v[80:83], v28 offset:4096
    ds_read_b128 v[84:87], v28 offset:5120
    ds_read_b128 v[88:91], v28 offset:6144
    ds_read_b128 v[92:95], v28 offset:7168
    ds_read_b128 v[96:99], v29 offset:0
    ds_read_b128 v[100:103], v29 offset:1024
    ds_read_b128 v[104:107], v29 offset:2048
    ds_read_b128 v[108:111], v29 offset:3072
    v_add_f32 v128, v128, v32
    v_add_f32 v129, v129, v33
    v_add_f32 v130, v130, v34
    v_add_f32 v131, v131, v35
    v_add_f32 v132, v132, v36
    v_add_f32 v133, v133, v37
    v_add_f32 v134, v134, v38
    v_add_f32 v135, v135, v39
    v_add_f32 v136, v136, v40
    v_add_f32 v137, v137, v41
    v_add_f32 v138, v138, v42
    v_add_f32 v139, v139, v43
    v_add_f32 v140, v140, v44
    v_add_f32 v141, v141, v45
    v_add_f32 v142, v142, v46
    v_add_f32 v143, v143, v47
    v_add_f32 v144, v144, v48
    v_add_f32 v145, v145, v49
    v_add_f32 v146, v146, v50
    v_add_f32 v147, v147, v51
    v_add_f32 v148, v148, v52
    v_add_f32 v149, v149, v53
    v_add_f32 v150, v150, v54
    v_add_f32 v151, v151, v55
    v_add_f32 v152, v152, v56
    v_add_f32 v153, v153, v57
    v_add_f32 v154, v154, v58
    v_add_f32 v155, v155, v59
    v_add_f32 v156, v156, v60
    v_add_f32 v157, v157, v61
    v_add_f32 v158, v158, v62
    v_add_f32 v159, v159, v63
    s_waitcnt lgkmcnt(4)
    ds_read_b128 v[112:115], v29 offset:4096
    ds_read_b128 v[116:119], v29 offset:5120
    ds_read_b128 v[120:123], v29 offset:6144
    ds_read_b128 v[124:127], v29 offset:7168
    v_add_f32 v128, v128, v64
    v_add_f32 v129, v129, v65
    v_add_f32 v130, v130, v66
    v_add_f32 v131, v131, v67
    v_add_f32 v132, v132, v68
    v_add_f32 v133, v133, v69
    v_add_f32 v134, v134, v70
    v_add_f32 v135, v135, v71
    v_add_f32 v136, v136, v72
    v_add_f32 v137, v137, v73
    v_add_f32 v138, v138, v74
    v_add_f32 v139, v139, v75
    v_add_f32 v140, v140, v76
    v_add_f32 v141, v141, v77
    v_add_f32 v142, v142, v78
    v_add_f32 v143, v143, v79
    v_add_f32 v144, v144, v80
    v_add_f32 v145, v145, v81
    v_add_f32 v146, v146, v82
    v_add_f32 v147, v147, v83
    v_add_f32 v148, v148, v84
    v_add_f32 v149, v149, v85
    v_add_f32 v150, v150, v86
    v_add_f32 v151, v151, v87
    v_add_f32 v152, v152, v88
    v_add_f32 v153, v153, v89
    v_add_f32 v154, v154, v90
    v_add_f32 v155, v155, v91
    v_add_f32 v156, v156, v92
    v_add_f32 v157, v157, v93
    v_add_f32 v158, v158, v94
    v_add_f32 v159, v159, v95
    s_waitcnt lgkmcnt(0)
    v_add_f32 v128, v128, v96
    v_add_f32 v129, v129, v97
    v_add_f32 v130, v130, v98
    v_add_f32 v131, v131, v99
    v_add_f32 v132, v132, v100
    v_add_f32 v133, v133, v101
    v_add_f32 v134, v134, v102
    v_add_f32 v135, v135, v103
    v_add_f32 v136, v136, v104
    v_add_f32 v137, v137, v105
    v_add_f32 v138, v138, v106
    v_add_f32 v139, v139, v107
    v_add_f32 v140, v140, v108
    v_add_f32 v141, v141, v109
    v_add_f32 v142, v142, v110
    v_add_f32 v143, v143, v111
    v_add_f32 v144, v144, v112
    v_add_f32 v145, v145, v113
    v_add_f32 v146, v146, v114
    v_add_f32 v147, v147, v115
    v_add_f32 v148, v148, v116
    v_add_f32 v149, v149, v117
    v_add_f32 v150, v150, v118
    v_add_f32 v151, v151, v119
    v_add_f32 v152, v152, v120
    v_add_f32 v153, v153, v121
    v_add_f32 v154, v154, v122
    v_add_f32 v155, v155, v123
    v_add_f32 v156, v156, v124
    v_add_f32 v157, v157, v125
    v_add_f32 v158, v158, v126
    v_add_f32 v159, v159, v127
    v_mul_f32 v32, s41, v128
    v_mul_f32 v33, s42, v136
    v_mul_f32 v34, s41, v132
    v_mul_f32 v35, s42, v140
    v_mul_f32 v36, s41, v129
    v_mul_f32 v37, s42, v137
    v_mul_f32 v38, s41, v133
    v_mul_f32 v39, s42, v141
    v_mul_f32 v40, s41, v130
    v_mul_f32 v41, s42, v138
    v_mul_f32 v42, s41, v134
    v_mul_f32 v43, s42, v142
    v_mul_f32 v44, s41, v131
    v_mul_f32 v45, s42, v139
    v_mul_f32 v46, s41, v135
    v_mul_f32 v47, s42, v143
    v_mul_f32 v48, s41, v144
    v_mul_f32 v49, s42, v152
    v_mul_f32 v50, s41, v148
    v_mul_f32 v51, s42, v156
    v_mul_f32 v52, s41, v145
    v_mul_f32 v53, s42, v153
    v_mul_f32 v54, s41, v149
    v_mul_f32 v55, s42, v157
    v_mul_f32 v56, s41, v146
    v_mul_f32 v57, s42, v154
    v_mul_f32 v58, s41, v150
    v_mul_f32 v59, s42, v158
    v_mul_f32 v60, s41, v147
    v_mul_f32 v61, s42, v155
    v_mul_f32 v62, s41, v151
    v_mul_f32 v63, s42, v159
    v_exp_f32 v32, v32
    v_exp_f32 v33, v33
    v_exp_f32 v34, v34
    v_exp_f32 v35, v35
    v_exp_f32 v36, v36
    v_exp_f32 v37, v37
    v_exp_f32 v38, v38
    v_exp_f32 v39, v39
    v_exp_f32 v40, v40
    v_exp_f32 v41, v41
    v_exp_f32 v42, v42
    v_exp_f32 v43, v43
    v_exp_f32 v44, v44
    v_exp_f32 v45, v45
    v_exp_f32 v46, v46
    v_exp_f32 v47, v47
    v_exp_f32 v48, v48
    v_exp_f32 v49, v49
    v_exp_f32 v50, v50
    v_exp_f32 v51, v51
    v_exp_f32 v52, v52
    v_exp_f32 v53, v53
    v_exp_f32 v54, v54
    v_exp_f32 v55, v55
    v_exp_f32 v56, v56
    v_exp_f32 v57, v57
    v_exp_f32 v58, v58
    v_exp_f32 v59, v59
    v_exp_f32 v60, v60
    v_exp_f32 v61, v61
    v_exp_f32 v62, v62
    v_exp_f32 v63, v63
    v_add_f32 v32, 1.0, v32
    v_add_f32 v33, 1.0, v33
    v_add_f32 v34, 1.0, v34
    v_add_f32 v35, 1.0, v35
    v_add_f32 v36, 1.0, v36
    v_add_f32 v37, 1.0, v37
    v_add_f32 v38, 1.0, v38
    v_add_f32 v39, 1.0, v39
    v_add_f32 v40, 1.0, v40
    v_add_f32 v41, 1.0, v41
    v_add_f32 v42, 1.0, v42
    v_add_f32 v43, 1.0, v43
    v_add_f32 v44, 1.0, v44
    v_add_f32 v45, 1.0, v45
    v_add_f32 v46, 1.0, v46
    v_add_f32 v47, 1.0, v47
    v_add_f32 v48, 1.0, v48
    v_add_f32 v49, 1.0, v49
    v_add_f32 v50, 1.0, v50
    v_add_f32 v51, 1.0, v51
    v_add_f32 v52, 1.0, v52
    v_add_f32 v53, 1.0, v53
    v_add_f32 v54, 1.0, v54
    v_add_f32 v55, 1.0, v55
    v_add_f32 v56, 1.0, v56
    v_add_f32 v57, 1.0, v57
    v_add_f32 v58, 1.0, v58
    v_add_f32 v59, 1.0, v59
    v_add_f32 v60, 1.0, v60
    v_add_f32 v61, 1.0, v61
    v_add_f32 v62, 1.0, v62
    v_add_f32 v63, 1.0, v63
    v_rcp_f32 v32, v32
    v_rcp_f32 v33, v33
    v_rcp_f32 v34, v34
    v_rcp_f32 v35, v35
    v_rcp_f32 v36, v36
    v_rcp_f32 v37, v37
    v_rcp_f32 v38, v38
    v_rcp_f32 v39, v39
    v_rcp_f32 v40, v40
    v_rcp_f32 v41, v41
    v_rcp_f32 v42, v42
    v_rcp_f32 v43, v43
    v_rcp_f32 v44, v44
    v_rcp_f32 v45, v45
    v_rcp_f32 v46, v46
    v_rcp_f32 v47, v47
    v_rcp_f32 v48, v48
    v_rcp_f32 v49, v49
    v_rcp_f32 v50, v50
    v_rcp_f32 v51, v51
    v_rcp_f32 v52, v52
    v_rcp_f32 v53, v53
    v_rcp_f32 v54, v54
    v_rcp_f32 v55, v55
    v_rcp_f32 v56, v56
    v_rcp_f32 v57, v57
    v_rcp_f32 v58, v58
    v_rcp_f32 v59, v59
    v_rcp_f32 v60, v60
    v_rcp_f32 v61, v61
    v_rcp_f32 v62, v62
    v_rcp_f32 v63, v63
    v_fma_f32 v32, v32, -2.0, 1.0
    v_fma_f32 v34, v34, -2.0, 1.0
    v_fma_f32 v36, v36, -2.0, 1.0
    v_fma_f32 v38, v38, -2.0, 1.0
    v_fma_f32 v40, v40, -2.0, 1.0
    v_fma_f32 v42, v42, -2.0, 1.0
    v_fma_f32 v44, v44, -2.0, 1.0
    v_fma_f32 v46, v46, -2.0, 1.0
    v_fma_f32 v48, v48, -2.0, 1.0
    v_fma_f32 v50, v50, -2.0, 1.0
    v_fma_f32 v52, v52, -2.0, 1.0
    v_fma_f32 v54, v54, -2.0, 1.0
    v_fma_f32 v56, v56, -2.0, 1.0
    v_fma_f32 v58, v58, -2.0, 1.0
    v_fma_f32 v60, v60, -2.0, 1.0
    v_fma_f32 v62, v62, -2.0, 1.0
    v_mul_f32 v32, v32, v33
    v_mul_f32 v34, v34, v35
    v_mul_f32 v36, v36, v37
    v_mul_f32 v38, v38, v39
    v_mul_f32 v40, v40, v41
    v_mul_f32 v42, v42, v43
    v_mul_f32 v44, v44, v45
    v_mul_f32 v46, v46, v47
    v_mul_f32 v48, v48, v49
    v_mul_f32 v50, v50, v51
    v_mul_f32 v52, v52, v53
    v_mul_f32 v54, v54, v55
    v_mul_f32 v56, v56, v57
    v_mul_f32 v58, v58, v59
    v_mul_f32 v60, v60, v61
    v_mul_f32 v62, v62, v63
    s_mov_b32 s40, 65536
    s_mov_b32 s43, 81920
    v_cvt_pk_bf16_f32 v64, v32, v34
    v_cvt_pk_bf16_f32 v65, v36, v38
    v_cvt_pk_bf16_f32 v66, v40, v42
    v_cvt_pk_bf16_f32 v67, v44, v46
    v_cvt_pk_bf16_f32 v68, v48, v50
    v_cvt_pk_bf16_f32 v69, v52, v54
    v_cvt_pk_bf16_f32 v70, v56, v58
    v_cvt_pk_bf16_f32 v71, v60, v62
    buffer_store_dword v64, v25, s[20:23], s40 offen
    buffer_store_dword v65, v25, s[20:23], s40 offen offset:1024
    buffer_store_dword v66, v25, s[20:23], s40 offen offset:2048
    buffer_store_dword v67, v25, s[20:23], s40 offen offset:3072
    buffer_store_dword v68, v25, s[20:23], s43 offen
    buffer_store_dword v69, v25, s[20:23], s43 offen offset:1024
    buffer_store_dword v70, v25, s[20:23], s43 offen offset:2048
    buffer_store_dword v71, v25, s[20:23], s43 offen offset:3072
    s_endpgm
L_fin3:
    ds_write_b128 v2, a[0:3] offset:0
    ds_write_b128 v2, a[4:7] offset:1024
    ds_write_b128 v2, a[8:11] offset:2048
    ds_write_b128 v2, a[12:15] offset:3072
    ds_write_b128 v2, a[16:19] offset:4096
    ds_write_b128 v2, a[20:23] offset:5120
    ds_write_b128 v2, a[24:27] offset:6144
    ds_write_b128 v2, a[28:31] offset:7168
    ds_write_b128 v2, a[32:35] offset:8192
    ds_write_b128 v2, a[36:39] offset:9216
    ds_write_b128 v2, a[40:43] offset:10240
    ds_write_b128 v2, a[44:47] offset:11264
    ds_write_b128 v2, a[48:51] offset:12288
    ds_write_b128 v2, a[52:55] offset:13312
    ds_write_b128 v2, a[56:59] offset:14336
    ds_write_b128 v2, a[60:63] offset:15360
    ds_write_b128 v2, a[64:67] offset:16384
    ds_write_b128 v2, a[68:71] offset:17408
    ds_write_b128 v2, a[72:75] offset:18432
    ds_write_b128 v2, a[76:79] offset:19456
    ds_write_b128 v2, a[80:83] offset:20480
    ds_write_b128 v2, a[84:87] offset:21504
    ds_write_b128 v2, a[88:91] offset:22528
    ds_write_b128 v2, a[92:95] offset:23552
    v_add_u32 v27, 24576, v26
    v_add_u32 v28, 59392, v26
    v_add_u32 v29, 94208, v26
    v_accvgpr_read_b32 v128, a96
    v_accvgpr_read_b32 v129, a97
    v_accvgpr_read_b32 v130, a98
    v_accvgpr_read_b32 v131, a99
    v_accvgpr_read_b32 v132, a100
    v_accvgpr_read_b32 v133, a101
    v_accvgpr_read_b32 v134, a102
    v_accvgpr_read_b32 v135, a103
    v_accvgpr_read_b32 v136, a104
    v_accvgpr_read_b32 v137, a105
    v_accvgpr_read_b32 v138, a106
    v_accvgpr_read_b32 v139, a107
    v_accvgpr_read_b32 v140, a108
    v_accvgpr_read_b32 v141, a109
    v_accvgpr_read_b32 v142, a110
    v_accvgpr_read_b32 v143, a111
    v_accvgpr_read_b32 v144, a112
    v_accvgpr_read_b32 v145, a113
    v_accvgpr_read_b32 v146, a114
    v_accvgpr_read_b32 v147, a115
    v_accvgpr_read_b32 v148, a116
    v_accvgpr_read_b32 v149, a117
    v_accvgpr_read_b32 v150, a118
    v_accvgpr_read_b32 v151, a119
    v_accvgpr_read_b32 v152, a120
    v_accvgpr_read_b32 v153, a121
    v_accvgpr_read_b32 v154, a122
    v_accvgpr_read_b32 v155, a123
    v_accvgpr_read_b32 v156, a124
    v_accvgpr_read_b32 v157, a125
    v_accvgpr_read_b32 v158, a126
    v_accvgpr_read_b32 v159, a127
    s_waitcnt lgkmcnt(0)
    s_barrier
    ds_read_b128 v[32:35], v27 offset:0
    ds_read_b128 v[36:39], v27 offset:1024
    ds_read_b128 v[40:43], v27 offset:2048
    ds_read_b128 v[44:47], v27 offset:3072
    ds_read_b128 v[48:51], v27 offset:4096
    ds_read_b128 v[52:55], v27 offset:5120
    ds_read_b128 v[56:59], v27 offset:6144
    ds_read_b128 v[60:63], v27 offset:7168
    ds_read_b128 v[64:67], v28 offset:0
    ds_read_b128 v[68:71], v28 offset:1024
    ds_read_b128 v[72:75], v28 offset:2048
    ds_read_b128 v[76:79], v28 offset:3072
    s_waitcnt lgkmcnt(4)
    ds_read_b128 v[80:83], v28 offset:4096
    ds_read_b128 v[84:87], v28 offset:5120
    ds_read_b128 v[88:91], v28 offset:6144
    ds_read_b128 v[92:95], v28 offset:7168
    ds_read_b128 v[96:99], v29 offset:0
    ds_read_b128 v[100:103], v29 offset:1024
    ds_read_b128 v[104:107], v29 offset:2048
    ds_read_b128 v[108:111], v29 offset:3072
    v_add_f32 v128, v128, v32
    v_add_f32 v129, v129, v33
    v_add_f32 v130, v130, v34
    v_add_f32 v131, v131, v35
    v_add_f32 v132, v132, v36
    v_add_f32 v133, v133, v37
    v_add_f32 v134, v134, v38
    v_add_f32 v135, v135, v39
    v_add_f32 v136, v136, v40
    v_add_f32 v137, v137, v41
    v_add_f32 v138, v138, v42
    v_add_f32 v139, v139, v43
    v_add_f32 v140, v140, v44
    v_add_f32 v141, v141, v45
    v_add_f32 v142, v142, v46
    v_add_f32 v143, v143, v47
    v_add_f32 v144, v144, v48
    v_add_f32 v145, v145, v49
    v_add_f32 v146, v146, v50
    v_add_f32 v147, v147, v51
    v_add_f32 v148, v148, v52
    v_add_f32 v149, v149, v53
    v_add_f32 v150, v150, v54
    v_add_f32 v151, v151, v55
    v_add_f32 v152, v152, v56
    v_add_f32 v153, v153, v57
    v_add_f32 v154, v154, v58
    v_add_f32 v155, v155, v59
    v_add_f32 v156, v156, v60
    v_add_f32 v157, v157, v61
    v_add_f32 v158, v158, v62
    v_add_f32 v159, v159, v63
    s_waitcnt lgkmcnt(4)
    ds_read_b128 v[112:115], v29 offset:4096
    ds_read_b128 v[116:119], v29 offset:5120
    ds_read_b128 v[120:123], v29 offset:6144
    ds_read_b128 v[124:127], v29 offset:7168
    v_add_f32 v128, v128, v64
    v_add_f32 v129, v129, v65
    v_add_f32 v130, v130, v66
    v_add_f32 v131, v131, v67
    v_add_f32 v132, v132, v68
    v_add_f32 v133, v133, v69
    v_add_f32 v134, v134, v70
    v_add_f32 v135, v135, v71
    v_add_f32 v136, v136, v72
    v_add_f32 v137, v137, v73
    v_add_f32 v138, v138, v74
    v_add_f32 v139, v139, v75
    v_add_f32 v140, v140, v76
    v_add_f32 v141, v141, v77
    v_add_f32 v142, v142, v78
    v_add_f32 v143, v143, v79
    v_add_f32 v144, v144, v80
    v_add_f32 v145, v145, v81
    v_add_f32 v146, v146, v82
    v_add_f32 v147, v147, v83
    v_add_f32 v148, v148, v84
    v_add_f32 v149, v149, v85
    v_add_f32 v150, v150, v86
    v_add_f32 v151, v151, v87
    v_add_f32 v152, v152, v88
    v_add_f32 v153, v153, v89
    v_add_f32 v154, v154, v90
    v_add_f32 v155, v155, v91
    v_add_f32 v156, v156, v92
    v_add_f32 v157, v157, v93
    v_add_f32 v158, v158, v94
    v_add_f32 v159, v159, v95
    s_waitcnt lgkmcnt(0)
    v_add_f32 v128, v128, v96
    v_add_f32 v129, v129, v97
    v_add_f32 v130, v130, v98
    v_add_f32 v131, v131, v99
    v_add_f32 v132, v132, v100
    v_add_f32 v133, v133, v101
    v_add_f32 v134, v134, v102
    v_add_f32 v135, v135, v103
    v_add_f32 v136, v136, v104
    v_add_f32 v137, v137, v105
    v_add_f32 v138, v138, v106
    v_add_f32 v139, v139, v107
    v_add_f32 v140, v140, v108
    v_add_f32 v141, v141, v109
    v_add_f32 v142, v142, v110
    v_add_f32 v143, v143, v111
    v_add_f32 v144, v144, v112
    v_add_f32 v145, v145, v113
    v_add_f32 v146, v146, v114
    v_add_f32 v147, v147, v115
    v_add_f32 v148, v148, v116
    v_add_f32 v149, v149, v117
    v_add_f32 v150, v150, v118
    v_add_f32 v151, v151, v119
    v_add_f32 v152, v152, v120
    v_add_f32 v153, v153, v121
    v_add_f32 v154, v154, v122
    v_add_f32 v155, v155, v123
    v_add_f32 v156, v156, v124
    v_add_f32 v157, v157, v125
    v_add_f32 v158, v158, v126
    v_add_f32 v159, v159, v127
    v_mul_f32 v32, s41, v128
    v_mul_f32 v33, s42, v136
    v_mul_f32 v34, s41, v132
    v_mul_f32 v35, s42, v140
    v_mul_f32 v36, s41, v129
    v_mul_f32 v37, s42, v137
    v_mul_f32 v38, s41, v133
    v_mul_f32 v39, s42, v141
    v_mul_f32 v40, s41, v130
    v_mul_f32 v41, s42, v138
    v_mul_f32 v42, s41, v134
    v_mul_f32 v43, s42, v142
    v_mul_f32 v44, s41, v131
    v_mul_f32 v45, s42, v139
    v_mul_f32 v46, s41, v135
    v_mul_f32 v47, s42, v143
    v_mul_f32 v48, s41, v144
    v_mul_f32 v49, s42, v152
    v_mul_f32 v50, s41, v148
    v_mul_f32 v51, s42, v156
    v_mul_f32 v52, s41, v145
    v_mul_f32 v53, s42, v153
    v_mul_f32 v54, s41, v149
    v_mul_f32 v55, s42, v157
    v_mul_f32 v56, s41, v146
    v_mul_f32 v57, s42, v154
    v_mul_f32 v58, s41, v150
    v_mul_f32 v59, s42, v158
    v_mul_f32 v60, s41, v147
    v_mul_f32 v61, s42, v155
    v_mul_f32 v62, s41, v151
    v_mul_f32 v63, s42, v159
    v_exp_f32 v32, v32
    v_exp_f32 v33, v33
    v_exp_f32 v34, v34
    v_exp_f32 v35, v35
    v_exp_f32 v36, v36
    v_exp_f32 v37, v37
    v_exp_f32 v38, v38
    v_exp_f32 v39, v39
    v_exp_f32 v40, v40
    v_exp_f32 v41, v41
    v_exp_f32 v42, v42
    v_exp_f32 v43, v43
    v_exp_f32 v44, v44
    v_exp_f32 v45, v45
    v_exp_f32 v46, v46
    v_exp_f32 v47, v47
    v_exp_f32 v48, v48
    v_exp_f32 v49, v49
    v_exp_f32 v50, v50
    v_exp_f32 v51, v51
    v_exp_f32 v52, v52
    v_exp_f32 v53, v53
    v_exp_f32 v54, v54
    v_exp_f32 v55, v55
    v_exp_f32 v56, v56
    v_exp_f32 v57, v57
    v_exp_f32 v58, v58
    v_exp_f32 v59, v59
    v_exp_f32 v60, v60
    v_exp_f32 v61, v61
    v_exp_f32 v62, v62
    v_exp_f32 v63, v63
    v_add_f32 v32, 1.0, v32
    v_add_f32 v33, 1.0, v33
    v_add_f32 v34, 1.0, v34
    v_add_f32 v35, 1.0, v35
    v_add_f32 v36, 1.0, v36
    v_add_f32 v37, 1.0, v37
    v_add_f32 v38, 1.0, v38
    v_add_f32 v39, 1.0, v39
    v_add_f32 v40, 1.0, v40
    v_add_f32 v41, 1.0, v41
    v_add_f32 v42, 1.0, v42
    v_add_f32 v43, 1.0, v43
    v_add_f32 v44, 1.0, v44
    v_add_f32 v45, 1.0, v45
    v_add_f32 v46, 1.0, v46
    v_add_f32 v47, 1.0, v47
    v_add_f32 v48, 1.0, v48
    v_add_f32 v49, 1.0, v49
    v_add_f32 v50, 1.0, v50
    v_add_f32 v51, 1.0, v51
    v_add_f32 v52, 1.0, v52
    v_add_f32 v53, 1.0, v53
    v_add_f32 v54, 1.0, v54
    v_add_f32 v55, 1.0, v55
    v_add_f32 v56, 1.0, v56
    v_add_f32 v57, 1.0, v57
    v_add_f32 v58, 1.0, v58
    v_add_f32 v59, 1.0, v59
    v_add_f32 v60, 1.0, v60
    v_add_f32 v61, 1.0, v61
    v_add_f32 v62, 1.0, v62
    v_add_f32 v63, 1.0, v63
    v_rcp_f32 v32, v32
    v_rcp_f32 v33, v33
    v_rcp_f32 v34, v34
    v_rcp_f32 v35, v35
    v_rcp_f32 v36, v36
    v_rcp_f32 v37, v37
    v_rcp_f32 v38, v38
    v_rcp_f32 v39, v39
    v_rcp_f32 v40, v40
    v_rcp_f32 v41, v41
    v_rcp_f32 v42, v42
    v_rcp_f32 v43, v43
    v_rcp_f32 v44, v44
    v_rcp_f32 v45, v45
    v_rcp_f32 v46, v46
    v_rcp_f32 v47, v47
    v_rcp_f32 v48, v48
    v_rcp_f32 v49, v49
    v_rcp_f32 v50, v50
    v_rcp_f32 v51, v51
    v_rcp_f32 v52, v52
    v_rcp_f32 v53, v53
    v_rcp_f32 v54, v54
    v_rcp_f32 v55, v55
    v_rcp_f32 v56, v56
    v_rcp_f32 v57, v57
    v_rcp_f32 v58, v58
    v_rcp_f32 v59, v59
    v_rcp_f32 v60, v60
    v_rcp_f32 v61, v61
    v_rcp_f32 v62, v62
    v_rcp_f32 v63, v63
    v_fma_f32 v32, v32, -2.0, 1.0
    v_fma_f32 v34, v34, -2.0, 1.0
    v_fma_f32 v36, v36, -2.0, 1.0
    v_fma_f32 v38, v38, -2.0, 1.0
    v_fma_f32 v40, v40, -2.0, 1.0
    v_fma_f32 v42, v42, -2.0, 1.0
    v_fma_f32 v44, v44, -2.0, 1.0
    v_fma_f32 v46, v46, -2.0, 1.0
    v_fma_f32 v48, v48, -2.0, 1.0
    v_fma_f32 v50, v50, -2.0, 1.0
    v_fma_f32 v52, v52, -2.0, 1.0
    v_fma_f32 v54, v54, -2.0, 1.0
    v_fma_f32 v56, v56, -2.0, 1.0
    v_fma_f32 v58, v58, -2.0, 1.0
    v_fma_f32 v60, v60, -2.0, 1.0
    v_fma_f32 v62, v62, -2.0, 1.0
    v_mul_f32 v32, v32, v33
    v_mul_f32 v34, v34, v35
    v_mul_f32 v36, v36, v37
    v_mul_f32 v38, v38, v39
    v_mul_f32 v40, v40, v41
    v_mul_f32 v42, v42, v43
    v_mul_f32 v44, v44, v45
    v_mul_f32 v46, v46, v47
    v_mul_f32 v48, v48, v49
    v_mul_f32 v50, v50, v51
    v_mul_f32 v52, v52, v53
    v_mul_f32 v54, v54, v55
    v_mul_f32 v56, v56, v57
    v_mul_f32 v58, v58, v59
    v_mul_f32 v60, v60, v61
    v_mul_f32 v62, v62, v63
    s_mov_b32 s40, 98304
    s_mov_b32 s43, 114688
    v_cvt_pk_bf16_f32 v64, v32, v34
    v_cvt_pk_bf16_f32 v65, v36, v38
    v_cvt_pk_bf16_f32 v66, v40, v42
    v_cvt_pk_bf16_f32 v67, v44, v46
    v_cvt_pk_bf16_f32 v68, v48, v50
    v_cvt_pk_bf16_f32 v69, v52, v54
    v_cvt_pk_bf16_f32 v70, v56, v58
    v_cvt_pk_bf16_f32 v71, v60, v62
    buffer_store_dword v64, v25, s[20:23], s40 offen
    buffer_store_dword v65, v25, s[20:23], s40 offen offset:1024
    buffer_store_dword v66, v25, s[20:23], s40 offen offset:2048
    buffer_store_dword v67, v25, s[20:23], s40 offen offset:3072
    buffer_store_dword v68, v25, s[20:23], s43 offen
    buffer_store_dword v69, v25, s[20:23], s43 offen offset:1024
    buffer_store_dword v70, v25, s[20:23], s43 offen offset:2048
    buffer_store_dword v71, v25, s[20:23], s43 offen offset:3072
    s_endpgm
L_end:
    s_endpgm
.section .rodata,"a"
.p2align 6
.amdhsa_kernel standalone__autoregressive_conv_wavernn__speech_kernel
  .amdhsa_next_free_vgpr 308
  .amdhsa_next_free_sgpr 64
  .amdhsa_accum_offset 180
  .amdhsa_group_segment_fixed_size 0
  .amdhsa_kernarg_size 40
  .amdhsa_user_sgpr_count 2
  .amdhsa_user_sgpr_kernarg_segment_ptr 1
  .amdhsa_system_sgpr_workgroup_id_x 1
.end_amdhsa_kernel
```
